```python
import torch

def _softmax(x, axis=-1):
    return torch.softmax(x, dim=axis)
def _gelu(x):
    return torch.nn.functional.gelu(x, approximate="tanh")
def _silu(x):
    return torch.nn.functional.silu(x)
def _sigmoid(x):
    return torch.sigmoid(x)
def _layernorm(x, axis=-1, eps=1e-5):
    m = x.mean(dim=axis, keepdim=True)
    v = x.var(dim=axis, keepdim=True, unbiased=False)
    return (x - m) / torch.sqrt(v + eps)
def _scatter_add(tgt, idx, src, axis=0):
    return tgt.clone().index_add_(axis, idx, src)
def _segment_sum(src, seg, n):
    out = torch.zeros((n,) + src.shape[1:], dtype=src.dtype)
    return out.index_add_(0, seg, src)
def _pad(x, pw):
    flat = tuple(v for pair in reversed(pw) for v in pair)
    return torch.nn.functional.pad(x, flat)

kernel_name = 'recurrent_scan__ssm_conv_h3__dense_activation_relu__prompt'

def setup_inputs():

    _w = (lambda a: (lambda t: t.to(torch.bfloat16) if t.is_floating_point() else t)(torch.as_tensor(a)))
    def _A_setup():
        B, S, D = 1, 2048, 640
        ks = 4
        return {
            "q": _w((lambda *s: torch.randn(*s, dtype=torch.bfloat16) * 0.05)(B, S, D)),
            "k": _w((lambda *s: torch.randn(*s, dtype=torch.bfloat16) * 0.2)(B, S, D)),
            "v": _w((lambda *s: torch.randn(*s, dtype=torch.bfloat16) * 0.2)(B, S, D)),
            "shift_k": _w((lambda *s: torch.randn(*s, dtype=torch.bfloat16) * 0.2)(D, ks) * 0.5),
            "ssm_k": _w((lambda *s: torch.randn(*s, dtype=torch.bfloat16) * 0.2)(D, S) * (1.0 / S ** 0.5)),
            "ssm_D": _w((lambda *s: torch.randn(*s, dtype=torch.bfloat16) * 0.2)(D)),
        }
    _A_in = _A_setup()

    def _B_setup():
        B, S, D, Dff = 1, 2048, 640, 1728
        return {
            "x": _w((lambda *s: torch.randn(*s, dtype=torch.bfloat16) * 0.05)(B, S, D)),
            "w1": _w((lambda *s: torch.randn(*s, dtype=torch.bfloat16) * 0.1)(D, Dff)),
            "w2": _w((lambda *s: torch.randn(*s, dtype=torch.bfloat16) * 0.1)(Dff, D)),
        }
    _B_in = _B_setup()

    return {
        "A_q": _A_in["q"],
        "A_k": _A_in["k"],
        "A_v": _A_in["v"],
        "A_shift_k": _A_in["shift_k"],
        "A_ssm_k": _A_in["ssm_k"],
        "A_ssm_D": _A_in["ssm_D"],
        "B_x": _B_in["x"],
        "B_w1": _B_in["w1"],
        "B_w2": _B_in["w2"],
    }

def reference(A_q, A_k, A_v, A_shift_k, A_ssm_k, A_ssm_D, B_x, B_w1, B_w2):
    def _A_ref(q, k, v, shift_k, ssm_k, ssm_D):
        B, S, D = q.shape
        ks = shift_k.shape[-1]
        k_pad = _pad(k, ((0, 0), (ks - 1, 0), (0, 0)))
        k_shift = torch.zeros_like(k)
        for t in range(ks):
            k_shift = k_shift + k_pad[:, t:t + S, :] * shift_k[:, ks - 1 - t][None, None, :]
        kv = k_shift * v
        L = 2 * S
        kv_pad = _pad(kv, ((0, 0), (0, S), (0, 0)))
        kf_pad = _pad(ssm_k, ((0, 0), (0, S)))
        kv_f = (lambda x, axes=(-2,-1): torch.fft.rfft2(x.float(), dim=axes))(kv_pad[:, None, :, :], axes=(1, 2))
        kf_f = (lambda x, axes=(-2,-1): torch.fft.rfft2(x.float(), dim=axes))(kf_pad[:, None, :], axes=(1, 2))
        kf_f = (lambda x, *d: x.permute(*d))(kf_f, 1, 2, 0)
        y_f = kv_f * kf_f[None, :, :, :]
        y = (lambda x, s, axes=(-2,-1): torch.fft.irfft2(x, s=s, dim=axes).to(torch.bfloat16))(y_f, (1, L), axes=(1, 2))[:, 0, :S, :]
        y = y + kv * ssm_D[None, None, :]
        return q * y

    def _B_ref(x, w1, w2):
        h = torch.einsum("bsd,df->bsf", x, w1)
        zero = torch.zeros_like(h)
        h = torch.maximum(h, zero)
        return torch.einsum("bsf,fd->bsd", h, w2)

    x = A_q
    xn = _layernorm(x, axis=-1)
    s = _A_ref(xn, A_k, A_v, A_shift_k, A_ssm_k, A_ssm_D)
    g = _silu(_B_ref(xn, B_w1, B_w2))
    return x + s * g
```

```asm
; @launch grid=(256,1,1) block=(512,1,1) lds=163840
.amdgcn_target "amdgcn-amd-amdhsa--gfx950"
.text
.globl recurrent_scan__ssm_conv_h3__dense_activation_relu__prompt_kernel
.p2align 8
.type recurrent_scan__ssm_conv_h3__dense_activation_relu__prompt_kernel,@function
recurrent_scan__ssm_conv_h3__dense_activation_relu__prompt_kernel:
    s_cmp_ge_u32 s2, 256
    s_cbranch_scc1 L_end
    s_load_dwordx16 s[16:31], s[0:1], 0
    s_load_dwordx8 s[32:39], s[0:1], 64
    v_lshrrev_b32 v1, 6, v0
    s_nop 0
    v_readfirstlane_b32 s3, v1
    v_and_b32 v0, 63, v0
    v_mov_b32 v4, 0
    v_mov_b32 v5, 0
    v_mov_b32 v6, 0
    v_mov_b32 v7, 0
    v_and_b32 v1, 3, v0
    v_lshlrev_b32 v1, 4, v1
    v_add_u32 v1, 163776, v1
    ds_write_b128 v1, v[4:7]
    s_and_b32 s4, s2, 7
    s_lshr_b32 s5, s2, 3
    s_lshr_b32 s10, s4, 1
    s_and_b32 s11, s4, 1
    s_lshl_b32 s6, s10, 2
    s_and_b32 s7, s5, 3
    s_add_u32 s6, s6, s7
    s_lshl_b32 s9, s11, 2
    s_add_u32 s9, s9, s7
    s_lshr_b32 s8, s5, 2
    s_mul_i32 s7, s11, 7
    s_add_u32 s7, s7, s8
    s_lshl_b32 s10, s10, 3
    s_add_u32 s8, s8, s10
    s_and_b32 s101, s3, 3
    s_mul_i32 s81, s101, 21248
    s_add_u32 s81, s81, 65536
    s_cmp_ge_u32 s2, 224
    s_cbranch_scc1 L_free
    s_cmp_lt_u32 s3, 4
    s_cbranch_scc1 L_a
    s_setprio 1
    v_lshrrev_b32 v10, 3, v0
    s_lshl_b32 s72, s101, 5
    v_add_u32 v10, s72, v10
    v_mul_u32_u24 v10, 1280, v10
    v_and_b32 v11, 7, v0
    v_lshrrev_b32 v12, 4, v0
    v_xor_b32 v13, v11, v12
    v_xor_b32 v14, 4, v13
    v_lshl_add_u32 v240, v13, 4, v10
    v_lshl_add_u32 v241, v14, 4, v10
    v_add_u32 v242, 18432, v240
    v_add_u32 v243, 27648, v241
    v_add_u32 v241, 9216, v241
    s_lshl_b32 s72, s101, 4
    v_add_u32 v10, s72, v12
    v_mul_u32_u24 v10, 3456, v10
    v_and_b32 v11, 1, v0
    v_lshl_add_u32 v10, v11, 4, v10
    v_bfe_u32 v11, v0, 1, 3
    v_xor_b32 v13, v11, v12
    v_xor_b32 v14, 4, v13
    v_lshl_add_u32 v244, v13, 5, v10
    v_lshl_add_u32 v246, v14, 5, v10
    s_cmp_eq_u32 s7, 13
    s_cselect_b32 s72, 0x40000000, 0
    v_mov_b32 v15, s72
    v_cmp_lt_u32 vcc, 3, v13
    s_nop 1
    v_cndmask_b32 v16, 0, v15, vcc
    v_sub_u32 v17, v15, v16
    v_add_u32 v244, v244, v16
    v_add_u32 v246, v246, v17
    v_add_u32 v245, 12800, v244
    v_add_u32 v247, 38400, v246
    v_add_u32 v246, 25600, v246
    s_mul_i32 s73, s6, 163840
    s_lshl_b32 s74, s7, 8
    s_lshl_b32 s75, s101, 12
    s_and_b32 s76, s5, 3
    s_lshr_b32 s77, s5, 2
    s_add_u32 s76, s76, s77
    s_and_b32 s76, s76, 3
    s_mov_b32 s78, 0x65832140
    s_mov_b32 s79, 0x97
    s_cmp_eq_u32 s76, 1
    s_cselect_b32 s78, 0x69432501, s78
    s_cselect_b32 s79, 0x87, s79
    s_cmp_eq_u32 s76, 2
    s_cselect_b32 s78, 0x75416032, s78
    s_cselect_b32 s79, 0x98, s79
    s_cmp_eq_u32 s76, 3
    s_cselect_b32 s78, 0x65471023, s78
    s_cselect_b32 s79, 0x98, s79
    s_lshl_b32 s80, s4, 2
    s_lshr_b32 s80, 0x38058350, s80
    s_and_b32 s80, s80, 15
    s_waitcnt lgkmcnt(0)
    s_mov_b32 s64, s16
    s_mov_b32 s65, s17
    s_mov_b32 s66, 0x280000
    s_mov_b32 s67, 0x20000
    s_mov_b32 s68, s30
    s_mov_b32 s69, s31
    s_mov_b32 s70, 0x21c000
    s_mov_b32 s71, 0x20000
    s_barrier
    s_and_b32 s76, s78, 15
    s_lshr_b64 s[78:79], s[78:79], 4
    s_add_u32 s76, s76, s80
    s_sub_u32 s77, s76, 10
    s_cmp_ge_u32 s76, 10
    s_cselect_b32 s76, s77, s76
    s_lshl_b32 s72, s76, 7
    s_add_u32 s72, s72, s73
    s_mul_i32 s77, s76, 221184
    s_add_u32 s77, s77, s74
    s_add_u32 m0, s75, 0
    s_nop 0
    buffer_load_dwordx4 v240, s[64:67], s72 offen offset:0 lds
    buffer_load_dwordx4 v241, s[64:67], s72 offen offset:1024 lds
    buffer_load_dwordx4 v242, s[64:67], s72 offen offset:2048 lds
    buffer_load_dwordx4 v243, s[64:67], s72 offen offset:3072 lds
    s_add_u32 m0, s75, 16384
    s_nop 0
    buffer_load_dwordx4 v244, s[68:71], s77 offen offset:0 lds
    buffer_load_dwordx4 v245, s[68:71], s77 offen offset:1024 lds
    buffer_load_dwordx4 v246, s[68:71], s77 offen offset:2048 lds
    buffer_load_dwordx4 v247, s[68:71], s77 offen offset:3072 lds
    s_add_u32 s92, s38, 0x1010000
    s_addc_u32 s93, s39, 0
    s_mov_b32 s94, 0x47800
    s_mov_b32 s95, 0x20000
    s_load_dwordx2 s[90:91], s[92:93], 40960
    v_mov_b32 v250, 163776
    s_lshl_b32 s10, s101, 2
    s_add_u32 s10, s10, 163824
    v_mov_b32 v248, s10
    s_add_u32 s40, s38, 0xa00000
    s_addc_u32 s41, s39, 0
    s_mov_b32 s42, 0x294000
    s_mov_b32 s43, 0x20000
    s_mul_i32 s52, s2, 6554
    s_lshr_b32 s52, s52, 16
    s_mul_i32 s53, s52, 10
    s_sub_u32 s53, s2, s53
    v_lshrrev_b32 v1, 3, v0
    v_and_b32 v3, 7, v0
    v_lshrrev_b32 v11, 1, v3
    v_sub_u32 v11, 3, v11
    v_mul_u32_u24 v11, 5120, v11
    v_lshl_add_u32 v11, v1, 5, v11
    v_and_b32 v12, 1, v3
    v_lshl_add_u32 v11, v12, 4, v11
    s_lshl_b32 s55, s101, 9
    s_add_u32 s55, s55, 131072
    v_add_u32 v211, s55, v11
    v_mul_u32_u24 v232, 4224, v1
    v_lshl_add_u32 v232, v3, 4, v232
    v_add_u32 v233, 33792, v232
    s_lshl_b32 s63, s53, 2
    s_add_u32 s63, s63, s101
    s_mul_i32 s63, s63, 67584
    s_lshl_b32 s55, s52, 7
    s_sub_u32 s55, 3968, s55
    s_add_u32 s63, s63, s55
    s_mov_b32 s84, s32
    s_mov_b32 s85, s33
    s_mov_b32 s86, 0x21c000
    s_mov_b32 s87, 0x20000
    s_add_u32 s44, s38, 0x700000
    s_addc_u32 s45, s39, 0
    s_mov_b32 s46, 0x21c000
    s_mov_b32 s47, 0x20000
    s_lshr_b32 s57, s2, 2
    s_and_b32 s58, s2, 3
    s_mul_i32 s59, s57, 40960
    s_mul_i32 s60, s58, 320
    s_add_u32 s59, s59, s60
    s_lshl_b32 s60, s101, 6
    s_lshl_b32 s61, s101, 10
    v_add_u32 v9, s60, v0
    v_mul_u32_u24 v10, 52429, v9
    v_lshrrev_b32 v10, 20, v10
    v_mul_u32_u24 v10, 960, v10
    v_lshl_add_u32 v110, v9, 4, v10
    v_add_u32 v9, s60, v0
    v_add_u32 v9, 256, v9
    v_mul_u32_u24 v10, 52429, v9
    v_lshrrev_b32 v10, 20, v10
    v_mul_u32_u24 v10, 960, v10
    v_lshl_add_u32 v111, v9, 4, v10
    v_add_u32 v9, s60, v0
    v_add_u32 v9, 512, v9
    v_mul_u32_u24 v10, 52429, v9
    v_lshrrev_b32 v10, 20, v10
    v_mul_u32_u24 v10, 960, v10
    v_lshl_add_u32 v112, v9, 4, v10
    s_cmp_ge_u32 s101, 2
    s_cselect_b32 s60, 1073741824, 0
    v_add_u32 v112, s60, v112
    v_lshrrev_b32 v11, 2, v0
    v_mul_u32_u24 v11, 320, v11
    v_and_b32 v12, 3, v0
    v_lshl_add_u32 v11, v12, 3, v11
    s_lshr_b32 s10, s101, 1
    s_and_b32 s11, s101, 1
    s_mul_i32 s60, s10, 5
    s_mul_i32 s54, s11, 3
    s_add_u32 s60, s60, s54
    s_lshl_b32 s60, s60, 5
    s_add_u32 s60, s60, 135168
    v_add_u32 v214, s60, v11
    s_lshl_b32 s60, s58, 1
    s_add_u32 s60, s60, s10
    s_mul_i32 s89, s60, 54
    s_add_u32 s89, s89, s57
    s_mul_i32 s89, s89, 5120
    s_lshl_b32 s54, s54, 10
    s_add_u32 s89, s89, s54
    s_cmp_ge_u32 s2, 216
    s_cselect_b32 s89, 1073741824, s89
    v_lshlrev_b32 v215, 4, v0
    s_cmp_eq_u32 s11, 1
    s_cselect_b32 s54, 1073741824, 0
    v_add_u32 v216, s54, v215
    s_lshl_b32 s82, s2, 1
    s_add_u32 s53, s2, 448
    s_cmp_lt_u32 s2, 64
    s_cselect_b32 s52, s53, 1000
    s_cselect_b32 s53, s53, s82
    s_lshr_b32 s10, s9, 1
    s_add_u32 s10, s10, 352
    v_lshl_add_u32 v224, v0, 2, s10
    v_mov_b32 v225, s10
    v_cmp_gt_u32 vcc, 54, v0
    s_nop 1
    v_cndmask_b32 v224, v225, v224, vcc
    v_lshlrev_b32 v224, 7, v224
    s_lshr_b32 s10, s82, 6
    s_lshr_b32 s11, s53, 6
    v_mov_b32 v225, s11
    v_mov_b32 v226, s10
    v_cmp_gt_u32 vcc, 32, v0
    s_nop 1
    v_cndmask_b32 v225, v225, v226, vcc
    v_and_b32 v226, 31, v0
    v_mad_u32_u24 v225, v226, 10, v225
    v_lshlrev_b32 v225, 7, v225
    s_add_u32 s82, s82, s101
    s_cmp_eq_u32 s101, 2
    s_cselect_b32 s82, s52, s82
    s_cmp_eq_u32 s101, 3
    s_cselect_b32 s82, 1000, s82
    s_lshl_b32 s83, s2, 7
    s_waitcnt lgkmcnt(0)
    s_mul_i32 s90, s90, 1664525
    s_add_u32 s90, s90, 1013904223
    s_mul_i32 s91, s91, 22695477
    s_add_u32 s91, s91, 1
    s_and_b32 s76, s78, 15
    s_lshr_b64 s[78:79], s[78:79], 4
    s_add_u32 s76, s76, s80
    s_sub_u32 s77, s76, 10
    s_cmp_ge_u32 s76, 10
    s_cselect_b32 s76, s77, s76
    s_lshl_b32 s72, s76, 7
    s_add_u32 s72, s72, s73
    s_mul_i32 s77, s76, 221184
    s_add_u32 s77, s77, s74
    s_add_u32 m0, s75, 32768
    s_nop 0
    buffer_load_dwordx4 v240, s[64:67], s72 offen offset:0 lds
    buffer_load_dwordx4 v241, s[64:67], s72 offen offset:1024 lds
    buffer_load_dwordx4 v242, s[64:67], s72 offen offset:2048 lds
    buffer_load_dwordx4 v243, s[64:67], s72 offen offset:3072 lds
    s_add_u32 m0, s75, 49152
    s_nop 0
    buffer_load_dwordx4 v244, s[68:71], s77 offen offset:0 lds
    buffer_load_dwordx4 v245, s[68:71], s77 offen offset:1024 lds
    buffer_load_dwordx4 v246, s[68:71], s77 offen offset:2048 lds
    buffer_load_dwordx4 v247, s[68:71], s77 offen offset:3072 lds
    s_cmp_eq_u32 s101, 2
    s_cselect_b32 s83, s83, 1073741824
    v_mov_b32 v249, 1
    s_lshl_b32 s88, s2, 7
    s_add_u32 s88, s88, 45056
    s_cmp_eq_u32 s101, 1
    s_cselect_b32 s88, s88, 1073741824
    s_waitcnt vmcnt(8)
    s_barrier
    s_and_b32 s76, s78, 15
    s_lshr_b64 s[78:79], s[78:79], 4
    s_add_u32 s76, s76, s80
    s_sub_u32 s77, s76, 10
    s_cmp_ge_u32 s76, 10
    s_cselect_b32 s76, s77, s76
    s_lshl_b32 s72, s76, 7
    s_add_u32 s72, s72, s73
    s_mul_i32 s77, s76, 221184
    s_add_u32 s77, s77, s74
    s_add_u32 m0, s75, 65536
    s_nop 0
    buffer_load_dwordx4 v240, s[64:67], s72 offen offset:0 lds
    buffer_load_dwordx4 v241, s[64:67], s72 offen offset:1024 lds
    buffer_load_dwordx4 v242, s[64:67], s72 offen offset:2048 lds
    buffer_load_dwordx4 v243, s[64:67], s72 offen offset:3072 lds
    s_add_u32 m0, s75, 81920
    s_nop 0
    buffer_load_dwordx4 v244, s[68:71], s77 offen offset:0 lds
    buffer_load_dwordx4 v245, s[68:71], s77 offen offset:1024 lds
    buffer_load_dwordx4 v246, s[68:71], s77 offen offset:2048 lds
    buffer_load_dwordx4 v247, s[68:71], s77 offen offset:3072 lds
    s_waitcnt vmcnt(8)
    s_barrier
    ds_read_b128 v[100:103], v211 offset:0
    ds_read_b128 v[104:107], v211 offset:256
    s_waitcnt lgkmcnt(0)
    buffer_store_dwordx4 v[100:103], v232, s[40:43], s63 offen sc1
    buffer_store_dwordx4 v[104:107], v233, s[40:43], s63 offen sc1
    s_and_b32 s76, s78, 15
    s_lshr_b64 s[78:79], s[78:79], 4
    s_add_u32 s76, s76, s80
    s_sub_u32 s77, s76, 10
    s_cmp_ge_u32 s76, 10
    s_cselect_b32 s76, s77, s76
    s_lshl_b32 s72, s76, 7
    s_add_u32 s72, s72, s73
    s_mul_i32 s77, s76, 221184
    s_add_u32 s77, s77, s74
    s_add_u32 m0, s75, 98304
    s_nop 0
    buffer_load_dwordx4 v240, s[64:67], s72 offen offset:0 lds
    buffer_load_dwordx4 v241, s[64:67], s72 offen offset:1024 lds
    buffer_load_dwordx4 v242, s[64:67], s72 offen offset:2048 lds
    buffer_load_dwordx4 v243, s[64:67], s72 offen offset:3072 lds
    s_add_u32 m0, s75, 114688
    s_nop 0
    buffer_load_dwordx4 v244, s[68:71], s77 offen offset:0 lds
    buffer_load_dwordx4 v245, s[68:71], s77 offen offset:1024 lds
    buffer_load_dwordx4 v246, s[68:71], s77 offen offset:2048 lds
    buffer_load_dwordx4 v247, s[68:71], s77 offen offset:3072 lds
    s_waitcnt vmcnt(10)
    s_barrier
    s_and_b32 s76, s78, 15
    s_lshr_b64 s[78:79], s[78:79], 4
    s_add_u32 s76, s76, s80
    s_sub_u32 s77, s76, 10
    s_cmp_ge_u32 s76, 10
    s_cselect_b32 s76, s77, s76
    s_lshl_b32 s72, s76, 7
    s_add_u32 s72, s72, s73
    s_mul_i32 s77, s76, 221184
    s_add_u32 s77, s77, s74
    s_add_u32 m0, s75, 0
    s_nop 0
    buffer_load_dwordx4 v240, s[64:67], s72 offen offset:0 lds
    buffer_load_dwordx4 v241, s[64:67], s72 offen offset:1024 lds
    buffer_load_dwordx4 v242, s[64:67], s72 offen offset:2048 lds
    buffer_load_dwordx4 v243, s[64:67], s72 offen offset:3072 lds
    s_add_u32 m0, s75, 16384
    s_nop 0
    buffer_load_dwordx4 v244, s[68:71], s77 offen offset:0 lds
    buffer_load_dwordx4 v245, s[68:71], s77 offen offset:1024 lds
    buffer_load_dwordx4 v246, s[68:71], s77 offen offset:2048 lds
    buffer_load_dwordx4 v247, s[68:71], s77 offen offset:3072 lds
    s_add_u32 m0, s61, 135168
    s_nop 0
    buffer_load_dwordx4 v110, s[84:87], s59 offen lds
    s_add_u32 m0, s61, 139264
    s_nop 0
    buffer_load_dwordx4 v111, s[84:87], s59 offen lds
    s_add_u32 m0, s61, 143360
    s_nop 0
    buffer_load_dwordx4 v112, s[84:87], s59 offen lds
    s_min_u32 s11, s82, 640
    s_lshl_b32 s10, s11, 12
    s_add_u32 s48, s24, s10
    s_addc_u32 s49, s25, 0
    s_sub_u32 s50, 2621440, s10
    s_mov_b32 s51, 0x20000
    v_and_b32 v2, 31, v0
    v_lshlrev_b32 v2, 7, v2
    buffer_load_dword v41, v2, s[48:51], 0 offen
    v_and_b32 v6, 15, v0
    v_lshrrev_b32 v7, 4, v0
    v_add_u32 v2, v6, v7
    v_lshlrev_b32 v2, 1, v2
    v_subrev_u32 v2, 32, v2
    buffer_load_ushort v40, v2, s[48:51], 0 offen
    s_waitcnt vmcnt(13)
    s_barrier
    s_and_b32 s76, s78, 15
    s_lshr_b64 s[78:79], s[78:79], 4
    s_add_u32 s76, s76, s80
    s_sub_u32 s77, s76, 10
    s_cmp_ge_u32 s76, 10
    s_cselect_b32 s76, s77, s76
    s_lshl_b32 s72, s76, 7
    s_add_u32 s72, s72, s73
    s_mul_i32 s77, s76, 221184
    s_add_u32 s77, s77, s74
    s_add_u32 m0, s75, 32768
    s_nop 0
    buffer_load_dwordx4 v240, s[64:67], s72 offen offset:0 lds
    buffer_load_dwordx4 v241, s[64:67], s72 offen offset:1024 lds
    buffer_load_dwordx4 v242, s[64:67], s72 offen offset:2048 lds
    buffer_load_dwordx4 v243, s[64:67], s72 offen offset:3072 lds
    s_add_u32 m0, s75, 49152
    s_nop 0
    buffer_load_dwordx4 v244, s[68:71], s77 offen offset:0 lds
    buffer_load_dwordx4 v245, s[68:71], s77 offen offset:1024 lds
    buffer_load_dwordx4 v246, s[68:71], s77 offen offset:2048 lds
    buffer_load_dwordx4 v247, s[68:71], s77 offen offset:3072 lds
    s_waitcnt vmcnt(13)
    s_barrier
    v_mov_b32 v4, s90
    v_mov_b32 v5, s91
    v_lshlrev_b32 v6, 3, v0
    s_bfm_b64 exec, 16, 0
    buffer_store_dwordx2 v[4:5], v6, s[92:95], s83 offen sc1
    s_mov_b64 exec, -1
    s_and_b32 s76, s78, 15
    s_lshr_b64 s[78:79], s[78:79], 4
    s_add_u32 s76, s76, s80
    s_sub_u32 s77, s76, 10
    s_cmp_ge_u32 s76, 10
    s_cselect_b32 s76, s77, s76
    s_lshl_b32 s72, s76, 7
    s_add_u32 s72, s72, s73
    s_mul_i32 s77, s76, 221184
    s_add_u32 s77, s77, s74
    s_add_u32 m0, s75, 65536
    s_nop 0
    buffer_load_dwordx4 v240, s[64:67], s72 offen offset:0 lds
    buffer_load_dwordx4 v241, s[64:67], s72 offen offset:1024 lds
    buffer_load_dwordx4 v242, s[64:67], s72 offen offset:2048 lds
    buffer_load_dwordx4 v243, s[64:67], s72 offen offset:3072 lds
    s_add_u32 m0, s75, 81920
    s_nop 0
    buffer_load_dwordx4 v244, s[68:71], s77 offen offset:0 lds
    buffer_load_dwordx4 v245, s[68:71], s77 offen offset:1024 lds
    buffer_load_dwordx4 v246, s[68:71], s77 offen offset:2048 lds
    buffer_load_dwordx4 v247, s[68:71], s77 offen offset:3072 lds
    s_waitcnt vmcnt(9)
    s_barrier
    s_and_b32 s76, s78, 15
    s_lshr_b64 s[78:79], s[78:79], 4
    s_add_u32 s76, s76, s80
    s_sub_u32 s77, s76, 10
    s_cmp_ge_u32 s76, 10
    s_cselect_b32 s76, s77, s76
    s_lshl_b32 s72, s76, 7
    s_add_u32 s72, s72, s73
    s_mul_i32 s77, s76, 221184
    s_add_u32 s77, s77, s74
    s_add_u32 m0, s75, 98304
    s_nop 0
    buffer_load_dwordx4 v240, s[64:67], s72 offen offset:0 lds
    buffer_load_dwordx4 v241, s[64:67], s72 offen offset:1024 lds
    buffer_load_dwordx4 v242, s[64:67], s72 offen offset:2048 lds
    buffer_load_dwordx4 v243, s[64:67], s72 offen offset:3072 lds
    s_add_u32 m0, s75, 114688
    s_nop 0
    buffer_load_dwordx4 v244, s[68:71], s77 offen offset:0 lds
    buffer_load_dwordx4 v245, s[68:71], s77 offen offset:1024 lds
    buffer_load_dwordx4 v246, s[68:71], s77 offen offset:2048 lds
    buffer_load_dwordx4 v247, s[68:71], s77 offen offset:3072 lds
    s_waitcnt vmcnt(8)
    s_barrier
    ds_read_b64_tr_b16 v[188:189], v214 offset:0
    ds_read_b64_tr_b16 v[190:191], v214 offset:5120
    ds_read_b64_tr_b16 v[192:193], v214 offset:32
    ds_read_b64_tr_b16 v[194:195], v214 offset:5152
    ds_read_b64_tr_b16 v[196:197], v214 offset:64
    ds_read_b64_tr_b16 v[198:199], v214 offset:5184
    s_and_b32 s76, s78, 15
    s_lshr_b64 s[78:79], s[78:79], 4
    s_add_u32 s76, s76, s80
    s_sub_u32 s77, s76, 10
    s_cmp_ge_u32 s76, 10
    s_cselect_b32 s76, s77, s76
    s_lshl_b32 s72, s76, 7
    s_add_u32 s72, s72, s73
    s_mul_i32 s77, s76, 221184
    s_add_u32 s77, s77, s74
    s_add_u32 m0, s75, 0
    s_nop 0
    buffer_load_dwordx4 v240, s[64:67], s72 offen offset:0 lds
    buffer_load_dwordx4 v241, s[64:67], s72 offen offset:1024 lds
    buffer_load_dwordx4 v242, s[64:67], s72 offen offset:2048 lds
    buffer_load_dwordx4 v243, s[64:67], s72 offen offset:3072 lds
    s_add_u32 m0, s75, 16384
    s_nop 0
    buffer_load_dwordx4 v244, s[68:71], s77 offen offset:0 lds
    buffer_load_dwordx4 v245, s[68:71], s77 offen offset:1024 lds
    buffer_load_dwordx4 v246, s[68:71], s77 offen offset:2048 lds
    buffer_load_dwordx4 v247, s[68:71], s77 offen offset:3072 lds
    s_waitcnt lgkmcnt(0)
    buffer_store_dwordx4 v[188:191], v215, s[44:47], s89 offen offset:0 sc1
    buffer_store_dwordx4 v[192:195], v215, s[44:47], s89 offen offset:1024 sc1
    buffer_store_dwordx4 v[196:199], v216, s[44:47], s89 offen offset:2048 sc1
    s_waitcnt vmcnt(11)
    s_barrier
    s_and_b32 s76, s78, 15
    s_lshr_b64 s[78:79], s[78:79], 4
    s_add_u32 s76, s76, s80
    s_sub_u32 s77, s76, 10
    s_cmp_ge_u32 s76, 10
    s_cselect_b32 s76, s77, s76
    s_lshl_b32 s72, s76, 7
    s_add_u32 s72, s72, s73
    s_mul_i32 s77, s76, 221184
    s_add_u32 s77, s77, s74
    s_add_u32 m0, s75, 32768
    s_nop 0
    buffer_load_dwordx4 v240, s[64:67], s72 offen offset:0 lds
    buffer_load_dwordx4 v241, s[64:67], s72 offen offset:1024 lds
    buffer_load_dwordx4 v242, s[64:67], s72 offen offset:2048 lds
    buffer_load_dwordx4 v243, s[64:67], s72 offen offset:3072 lds
    s_add_u32 m0, s75, 49152
    s_nop 0
    buffer_load_dwordx4 v244, s[68:71], s77 offen offset:0 lds
    buffer_load_dwordx4 v245, s[68:71], s77 offen offset:1024 lds
    buffer_load_dwordx4 v246, s[68:71], s77 offen offset:2048 lds
    buffer_load_dwordx4 v247, s[68:71], s77 offen offset:3072 lds
    s_cmp_lt_u32 s82, 640
    s_cbranch_scc1 L_b_hasconv
    s_waitcnt vmcnt(8)
    s_barrier
    s_cmp_eq_u32 s101, 3
    s_cbranch_scc1 L_b_w7
    s_waitcnt vmcnt(0)
    v_mov_b32 v251, 1
    s_mov_b64 exec, 1
    ds_write_b32 v248, v251
    s_mov_b64 exec, -1
    s_waitcnt vmcnt(0)
    v_mov_b32 v251, 2
    s_mov_b64 exec, 1
    ds_write_b32 v248, v251
    s_mov_b64 exec, -1
    s_branch L_b_aprep
L_b_w7:
    s_setprio 3
    s_lshl_b32 s83, s2, 7
    s_add_u32 s83, s83, 45056
    v_mov_b32 v4, s90
    v_mov_b32 v5, s91
    v_lshlrev_b32 v6, 3, v0
    s_bfm_b64 exec, 16, 0
    buffer_store_dwordx2 v[4:5], v6, s[92:95], s83 offen sc1
    s_mov_b64 exec, -1
    buffer_load_dwordx2 v[228:229], v225, s[92:95], 0 offen sc1
    s_waitcnt vmcnt(2)
    v_mov_b32 v251, 1
    s_mov_b64 exec, 1
    ds_write_b32 v248, v251
    s_mov_b64 exec, -1
    s_waitcnt vmcnt(0)
    v_mov_b32 v251, 2
    s_mov_b64 exec, 1
    ds_write_b32 v248, v251
    s_mov_b64 exec, -1
    v_cmp_ne_u64 vcc, s[90:91], v[228:229]
    s_nop 0
    s_cmp_eq_u64 vcc, 0
    s_cbranch_scc0 L_b_n1
    ds_write_b32 v250, v249 offset:16
L_b_n1:
    s_mov_b32 s10, 0
    s_branch L_bw0_chk
L_bw0:
    buffer_load_dwordx2 v[228:229], v225, s[92:95], 0 offen sc1
    s_waitcnt vmcnt(0)
L_bw0_chk:
    v_cmp_ne_u64 vcc, s[90:91], v[228:229]
    s_nop 0
    s_and_b64 exec, exec, vcc
    s_cbranch_scc0 L_bw0_ok
    s_sleep 4
    s_add_u32 s10, s10, 1
    s_cmp_lt_u32 s10, 0x20000
    s_cbranch_scc1 L_bw0
L_bw0_ok:
    s_mov_b64 exec, -1
    ds_write_b32 v250, v249 offset:16
    s_mov_b32 s10, 0
    s_cmp_ge_u32 s10, 12
    s_cbranch_scc1 L_b_evt_ok
L_b_evt:
    s_sleep 2
    ds_read_b128 v[252:255], v250 offset:32
    s_waitcnt lgkmcnt(0)
    v_min3_u32 v252, v252, v253, v254
    v_min_u32 v252, v252, v255
    s_nop 0
    v_readfirstlane_b32 s10, v252
    s_nop 0
    s_cmp_lt_u32 s10, 12
    s_cbranch_scc1 L_b_evt
L_b_evt_ok:
    buffer_load_dwordx2 v[230:231], v224, s[92:95], 0 offen sc1
    s_waitcnt vmcnt(0)
    s_mov_b32 s10, 0
    s_branch L_bwa_chk
L_bwa:
    buffer_load_dwordx2 v[228:229], v225, s[92:95], 0 offen sc1
    s_waitcnt vmcnt(0)
L_bwa_chk:
    v_cmp_ne_u64 vcc, s[90:91], v[228:229]
    s_nop 0
    s_and_b64 exec, exec, vcc
    s_cbranch_scc0 L_bwa_ok
    s_sleep 4
    s_add_u32 s10, s10, 1
    s_cmp_lt_u32 s10, 0x20000
    s_cbranch_scc1 L_bwa
L_bwa_ok:
    s_mov_b64 exec, -1
    v_mov_b32 v228, 163776
    v_mov_b32 v229, 1
    ds_write_b32 v228, v229 offset:16
    s_mov_b32 s10, 0
    s_branch L_bwb_chk
L_bwb:
    buffer_load_dwordx2 v[230:231], v224, s[92:95], 0 offen sc1
    s_waitcnt vmcnt(0)
L_bwb_chk:
    v_cmp_ne_u64 vcc, s[90:91], v[230:231]
    s_nop 0
    s_and_b64 exec, exec, vcc
    s_cbranch_scc0 L_bwb_ok
    s_sleep 4
    s_add_u32 s10, s10, 1
    s_cmp_lt_u32 s10, 0x20000
    s_cbranch_scc1 L_bwb
L_bwb_ok:
    s_mov_b64 exec, -1
    ds_write_b32 v228, v229 offset:12
    s_cmp_lg_u32 s2, 0
    s_cbranch_scc1 L_b_aprep
    s_setprio 0
    v_lshlrev_b32 v1, 7, v0
    s_mov_b32 s83, 45056
L_ep_next:
    s_mov_b32 s10, 0
L_ep:
    buffer_load_dwordx2 v[4:5], v1, s[92:95], s83 offen sc1
    s_waitcnt vmcnt(0)
L_ep_chk:
    v_cmp_ne_u64 vcc, s[90:91], v[4:5]
    s_nop 0
    s_and_b64 exec, exec, vcc
    s_cbranch_scc0 L_ep_ok
    s_sleep 16
    s_add_u32 s10, s10, 1
    s_cmp_lt_u32 s10, 0x20000
    s_cbranch_scc1 L_ep
L_ep_ok:
    s_mov_b64 exec, -1
    s_add_u32 s83, s83, 8192
    s_cmp_lt_u32 s83, 77824
    s_cbranch_scc1 L_ep_next
    s_mov_b32 s83, 40960
    v_mov_b32 v4, s90
    v_mov_b32 v5, s91
    v_lshlrev_b32 v6, 3, v0
    s_bfm_b64 exec, 16, 0
    buffer_store_dwordx2 v[4:5], v6, s[92:95], s83 offen sc1
    s_mov_b64 exec, -1
    s_branch L_b_aprep
L_b_hasconv:
    s_mov_b32 s60, s48
    s_mov_b32 s61, s49
    s_mov_b32 s62, s50
    s_mov_b32 s63, 0x20000
    s_add_u32 s64, s38, 0xa00000
    s_addc_u32 s65, s39, 0
    s_mov_b32 s66, 0x294000
    s_mov_b32 s67, 0x20000
    s_add_u32 s68, s38, 0xd00000
    s_addc_u32 s69, s39, 0
    s_mov_b32 s70, 0x294000
    s_mov_b32 s71, 0x20000
    s_and_b32 s73, s82, 0xfffe
    s_lshl_b32 s73, s73, 1
    s_load_dword s74, s[26:27], s73
    v_lshlrev_b32 v1, 4, v0
    v_and_b32 v6, 15, v0
    v_lshrrev_b32 v7, 4, v0
    s_mul_i32 s72, s82, 4224
    s_waitcnt vmcnt(8)
    s_barrier
    v_mul_u32_u24 v42, 4160, v7
    v_lshl_add_u32 v42, v6, 1, v42
    v_add_u32 v42, s81, v42
    v_lshlrev_b32 v43, 3, v0
    v_add_u32 v43, s81, v43
    v_add_u32 v3, 1, v6
    v_and_b32 v4, 1, v3
    v_mul_u32_u24 v4, 4160, v4
    v_and_b32 v3, 0x1e, v3
    v_lshl_add_u32 v3, v3, 1, v4
    v_lshl_add_u32 v3, v7, 4, v3
    v_add_u32 v168, s81, v3
    v_add_u32 v169, 1024, v168
    v_add_u32 v170, 2048, v168
    v_add_u32 v171, 3072, v168
    v_lshlrev_b32 v6, 5, v6
    s_add_u32 s75, s81, 17120
    v_sub_u32 v4, s75, v6
    v_lshlrev_b32 v5, 3, v7
    v_sub_u32 v5, v4, v5
    v_add_u32 v5, 24, v5
    v_lshl_add_u32 v4, v7, 4, v4
    v_and_b32 v2, 1, v7
    v_lshl_add_u32 v6, v2, 9, v6
    v_lshrrev_b32 v7, 1, v7
    v_lshl_add_u32 v6, v7, 4, v6
    v_mov_b32 v8, 0
    v_mov_b32 v9, 0
    v_mov_b32 v10, 0
    v_mov_b32 v11, 0
    v_mov_b32 v12, 0
    v_mov_b32 v13, 0
    v_mov_b32 v14, 0
    v_mov_b32 v15, 0
    v_mov_b32 v16, 0
    v_mov_b32 v17, 0
    v_mov_b32 v18, 0
    v_mov_b32 v19, 0
    v_mov_b32 v20, 0
    v_mov_b32 v21, 0
    v_mov_b32 v22, 0
    v_mov_b32 v23, 0
    v_mov_b32 v24, 0
    v_mov_b32 v25, 0
    v_mov_b32 v26, 0
    v_mov_b32 v27, 0
    v_mov_b32 v28, 0
    v_mov_b32 v29, 0
    v_mov_b32 v30, 0
    v_mov_b32 v31, 0
    v_mov_b32 v32, 0
    v_mov_b32 v33, 0
    v_mov_b32 v34, 0
    v_mov_b32 v35, 0
    v_mov_b32 v36, 0
    v_mov_b32 v37, 0
    v_mov_b32 v38, 0
    v_mov_b32 v39, 0
    s_waitcnt vmcnt(0)
    v_mov_b32 v251, 1
    s_mov_b64 exec, 1
    ds_write_b32 v248, v251
    s_mov_b64 exec, -1
    s_waitcnt vmcnt(0)
    v_mov_b32 v251, 2
    s_mov_b64 exec, 1
    ds_write_b32 v248, v251
    s_mov_b64 exec, -1
L_b_conv:
    v_mov_b32 v250, 163776
    s_add_u32 m0, s81, 32
    s_mov_b32 s75, 0
    buffer_load_dwordx4 v1, s[60:63], s75 offen offset:0 lds
    buffer_load_dwordx4 v1, s[60:63], s75 offen offset:1024 lds
    buffer_load_dwordx4 v1, s[60:63], s75 offen offset:2048 lds
    buffer_load_dwordx4 v1, s[60:63], s75 offen offset:3072 lds
    s_add_u32 m0, s81, 4192
    s_mov_b32 s75, 2
    buffer_load_dwordx4 v1, s[60:63], s75 offen offset:0 lds
    buffer_load_dwordx4 v1, s[60:63], s75 offen offset:1024 lds
    buffer_load_dwordx4 v1, s[60:63], s75 offen offset:2048 lds
    buffer_load_dwordx4 v1, s[60:63], s75 offen offset:3072 lds
    s_waitcnt vmcnt(8)
    ds_write_b16 v42, v40
    ds_write_b64 v43, v[8:9] offset:20736
L_b_c2:
L_b_uw:
    ds_read_b32 v251, v250 offset:16
    s_waitcnt lgkmcnt(0)
    v_readfirstlane_b32 s80, v251
    s_nop 0
    s_cmp_lg_u32 s80, 0
    s_cbranch_scc1 L_b_uw_ok
    s_sleep 2
    s_branch L_b_uw
L_b_uw_ok:
    s_add_u32 m0, s81, 16640
    s_nop 0
    buffer_load_dwordx4 v1, s[64:67], s72 offen offset:0 sc1 lds
    buffer_load_dwordx4 v1, s[64:67], s72 offen offset:1024 sc1 lds
    buffer_load_dwordx4 v1, s[64:67], s72 offen offset:2048 sc1 lds
    buffer_load_dwordx4 v1, s[64:67], s72 offen offset:3072 sc1 lds
    s_waitcnt vmcnt(0)
    ds_write_b32 v250, v250 offset:24
    s_setprio 1
    ds_read2_b32 v[40:41], v168 offset0:0 offset1:1
    ds_read2_b32 v[42:43], v168 offset0:2 offset1:3
    ds_read_b128 v[72:75], v4 offset:3584
    ds_read2_b32 v[44:45], v168 offset0:128 offset1:129
    ds_read2_b32 v[46:47], v168 offset0:130 offset1:131
    ds_read_b128 v[76:79], v4 offset:3072
    ds_read2_b32 v[48:49], v169 offset0:0 offset1:1
    ds_read2_b32 v[50:51], v169 offset0:2 offset1:3
    ds_read_b128 v[80:83], v4 offset:2560
    ds_read2_b32 v[52:53], v169 offset0:128 offset1:129
    ds_read2_b32 v[54:55], v169 offset0:130 offset1:131
    ds_read_b128 v[84:87], v4 offset:2048
    ds_read2_b32 v[56:57], v170 offset0:0 offset1:1
    ds_read2_b32 v[58:59], v170 offset0:2 offset1:3
    ds_read_b128 v[88:91], v4 offset:1536
    ds_read2_b32 v[60:61], v170 offset0:128 offset1:129
    ds_read2_b32 v[62:63], v170 offset0:130 offset1:131
    ds_read_b128 v[92:95], v4 offset:1024
    ds_read2_b32 v[64:65], v171 offset0:0 offset1:1
    ds_read2_b32 v[66:67], v171 offset0:2 offset1:3
    ds_read_b128 v[96:99], v4 offset:512
    ds_read2_b32 v[68:69], v171 offset0:128 offset1:129
    ds_read2_b32 v[70:71], v171 offset0:130 offset1:131
    ds_read_b128 v[100:103], v4 offset:0
    s_mov_b32 s75, 0
L_conv_loop_f:
    s_waitcnt lgkmcnt(0)
    v_mfma_f32_16x16x32_bf16 v[8:11], v[40:43], v[72:75], v[8:11]
    ds_read2_b32 v[104:105], v168 offset0:16 offset1:17
    v_mfma_f32_16x16x32_bf16 v[12:15], v[40:43], v[76:79], v[12:15]
    ds_read2_b32 v[106:107], v168 offset0:18 offset1:19
    v_mfma_f32_16x16x32_bf16 v[16:19], v[40:43], v[80:83], v[16:19]
    ds_read_b128 v[136:139], v4 offset:3648
    v_mfma_f32_16x16x32_bf16 v[20:23], v[40:43], v[84:87], v[20:23]
    ds_read2_b32 v[108:109], v168 offset0:144 offset1:145
    v_mfma_f32_16x16x32_bf16 v[24:27], v[40:43], v[88:91], v[24:27]
    ds_read2_b32 v[110:111], v168 offset0:146 offset1:147
    v_mfma_f32_16x16x32_bf16 v[28:31], v[40:43], v[92:95], v[28:31]
    ds_read_b128 v[140:143], v4 offset:3136
    v_mfma_f32_16x16x32_bf16 v[32:35], v[40:43], v[96:99], v[32:35]
    ds_read2_b32 v[112:113], v169 offset0:16 offset1:17
    v_mfma_f32_16x16x32_bf16 v[36:39], v[40:43], v[100:103], v[36:39]
    ds_read2_b32 v[114:115], v169 offset0:18 offset1:19
    v_mfma_f32_16x16x32_bf16 v[12:15], v[44:47], v[72:75], v[12:15]
    ds_read_b128 v[144:147], v4 offset:2624
    v_mfma_f32_16x16x32_bf16 v[16:19], v[44:47], v[76:79], v[16:19]
    ds_read2_b32 v[116:117], v169 offset0:144 offset1:145
    v_mfma_f32_16x16x32_bf16 v[20:23], v[44:47], v[80:83], v[20:23]
    ds_read2_b32 v[118:119], v169 offset0:146 offset1:147
    v_mfma_f32_16x16x32_bf16 v[24:27], v[44:47], v[84:87], v[24:27]
    ds_read_b128 v[148:151], v4 offset:2112
    v_mfma_f32_16x16x32_bf16 v[28:31], v[44:47], v[88:91], v[28:31]
    ds_read2_b32 v[120:121], v170 offset0:16 offset1:17
    v_mfma_f32_16x16x32_bf16 v[32:35], v[44:47], v[92:95], v[32:35]
    ds_read2_b32 v[122:123], v170 offset0:18 offset1:19
    v_mfma_f32_16x16x32_bf16 v[36:39], v[44:47], v[96:99], v[36:39]
    ds_read_b128 v[152:155], v4 offset:1600
    v_mfma_f32_16x16x32_bf16 v[16:19], v[48:51], v[72:75], v[16:19]
    ds_read2_b32 v[124:125], v170 offset0:144 offset1:145
    v_mfma_f32_16x16x32_bf16 v[20:23], v[48:51], v[76:79], v[20:23]
    ds_read2_b32 v[126:127], v170 offset0:146 offset1:147
    v_mfma_f32_16x16x32_bf16 v[24:27], v[48:51], v[80:83], v[24:27]
    ds_read_b128 v[156:159], v4 offset:1088
    v_mfma_f32_16x16x32_bf16 v[28:31], v[48:51], v[84:87], v[28:31]
    ds_read2_b32 v[128:129], v171 offset0:16 offset1:17
    v_mfma_f32_16x16x32_bf16 v[32:35], v[48:51], v[88:91], v[32:35]
    ds_read2_b32 v[130:131], v171 offset0:18 offset1:19
    v_mfma_f32_16x16x32_bf16 v[36:39], v[48:51], v[92:95], v[36:39]
    ds_read_b128 v[160:163], v4 offset:576
    v_mfma_f32_16x16x32_bf16 v[20:23], v[52:55], v[72:75], v[20:23]
    ds_read2_b32 v[132:133], v171 offset0:144 offset1:145
    v_mfma_f32_16x16x32_bf16 v[24:27], v[52:55], v[76:79], v[24:27]
    ds_read2_b32 v[134:135], v171 offset0:146 offset1:147
    v_mfma_f32_16x16x32_bf16 v[28:31], v[52:55], v[80:83], v[28:31]
    ds_read_b128 v[164:167], v4 offset:64
    v_mfma_f32_16x16x32_bf16 v[32:35], v[52:55], v[84:87], v[32:35]
    v_mfma_f32_16x16x32_bf16 v[36:39], v[52:55], v[88:91], v[36:39]
    v_mfma_f32_16x16x32_bf16 v[24:27], v[56:59], v[72:75], v[24:27]
    v_mfma_f32_16x16x32_bf16 v[28:31], v[56:59], v[76:79], v[28:31]
    v_mfma_f32_16x16x32_bf16 v[32:35], v[56:59], v[80:83], v[32:35]
    v_mfma_f32_16x16x32_bf16 v[36:39], v[56:59], v[84:87], v[36:39]
    v_mfma_f32_16x16x32_bf16 v[28:31], v[60:63], v[72:75], v[28:31]
    v_mfma_f32_16x16x32_bf16 v[32:35], v[60:63], v[76:79], v[32:35]
    v_mfma_f32_16x16x32_bf16 v[36:39], v[60:63], v[80:83], v[36:39]
    v_mfma_f32_16x16x32_bf16 v[32:35], v[64:67], v[72:75], v[32:35]
    v_mfma_f32_16x16x32_bf16 v[36:39], v[64:67], v[76:79], v[36:39]
    v_mfma_f32_16x16x32_bf16 v[36:39], v[68:71], v[72:75], v[36:39]
    s_waitcnt lgkmcnt(0)
    v_mfma_f32_16x16x32_bf16 v[8:11], v[104:107], v[136:139], v[8:11]
    ds_read2_b32 v[40:41], v168 offset0:32 offset1:33
    v_mfma_f32_16x16x32_bf16 v[12:15], v[104:107], v[140:143], v[12:15]
    ds_read2_b32 v[42:43], v168 offset0:34 offset1:35
    v_mfma_f32_16x16x32_bf16 v[16:19], v[104:107], v[144:147], v[16:19]
    ds_read_b128 v[72:75], v4 offset:3712
    v_mfma_f32_16x16x32_bf16 v[20:23], v[104:107], v[148:151], v[20:23]
    ds_read2_b32 v[44:45], v168 offset0:160 offset1:161
    v_mfma_f32_16x16x32_bf16 v[24:27], v[104:107], v[152:155], v[24:27]
    ds_read2_b32 v[46:47], v168 offset0:162 offset1:163
    v_mfma_f32_16x16x32_bf16 v[28:31], v[104:107], v[156:159], v[28:31]
    ds_read_b128 v[76:79], v4 offset:3200
    v_mfma_f32_16x16x32_bf16 v[32:35], v[104:107], v[160:163], v[32:35]
    ds_read2_b32 v[48:49], v169 offset0:32 offset1:33
    v_mfma_f32_16x16x32_bf16 v[36:39], v[104:107], v[164:167], v[36:39]
    ds_read2_b32 v[50:51], v169 offset0:34 offset1:35
    v_mfma_f32_16x16x32_bf16 v[12:15], v[108:111], v[136:139], v[12:15]
    ds_read_b128 v[80:83], v4 offset:2688
    v_mfma_f32_16x16x32_bf16 v[16:19], v[108:111], v[140:143], v[16:19]
    ds_read2_b32 v[52:53], v169 offset0:160 offset1:161
    v_mfma_f32_16x16x32_bf16 v[20:23], v[108:111], v[144:147], v[20:23]
    ds_read2_b32 v[54:55], v169 offset0:162 offset1:163
    v_mfma_f32_16x16x32_bf16 v[24:27], v[108:111], v[148:151], v[24:27]
    ds_read_b128 v[84:87], v4 offset:2176
    v_mfma_f32_16x16x32_bf16 v[28:31], v[108:111], v[152:155], v[28:31]
    ds_read2_b32 v[56:57], v170 offset0:32 offset1:33
    v_mfma_f32_16x16x32_bf16 v[32:35], v[108:111], v[156:159], v[32:35]
    ds_read2_b32 v[58:59], v170 offset0:34 offset1:35
    v_mfma_f32_16x16x32_bf16 v[36:39], v[108:111], v[160:163], v[36:39]
    ds_read_b128 v[88:91], v4 offset:1664
    v_mfma_f32_16x16x32_bf16 v[16:19], v[112:115], v[136:139], v[16:19]
    ds_read2_b32 v[60:61], v170 offset0:160 offset1:161
    v_mfma_f32_16x16x32_bf16 v[20:23], v[112:115], v[140:143], v[20:23]
    ds_read2_b32 v[62:63], v170 offset0:162 offset1:163
    v_mfma_f32_16x16x32_bf16 v[24:27], v[112:115], v[144:147], v[24:27]
    ds_read_b128 v[92:95], v4 offset:1152
    v_mfma_f32_16x16x32_bf16 v[28:31], v[112:115], v[148:151], v[28:31]
    ds_read2_b32 v[64:65], v171 offset0:32 offset1:33
    v_mfma_f32_16x16x32_bf16 v[32:35], v[112:115], v[152:155], v[32:35]
    ds_read2_b32 v[66:67], v171 offset0:34 offset1:35
    v_mfma_f32_16x16x32_bf16 v[36:39], v[112:115], v[156:159], v[36:39]
    ds_read_b128 v[96:99], v4 offset:640
    v_mfma_f32_16x16x32_bf16 v[20:23], v[116:119], v[136:139], v[20:23]
    ds_read2_b32 v[68:69], v171 offset0:160 offset1:161
    v_mfma_f32_16x16x32_bf16 v[24:27], v[116:119], v[140:143], v[24:27]
    ds_read2_b32 v[70:71], v171 offset0:162 offset1:163
    v_mfma_f32_16x16x32_bf16 v[28:31], v[116:119], v[144:147], v[28:31]
    ds_read_b128 v[100:103], v4 offset:128
    v_mfma_f32_16x16x32_bf16 v[32:35], v[116:119], v[148:151], v[32:35]
    v_add_u32 v168, 128, v168
    v_mfma_f32_16x16x32_bf16 v[36:39], v[116:119], v[152:155], v[36:39]
    v_add_u32 v169, 128, v169
    v_mfma_f32_16x16x32_bf16 v[24:27], v[120:123], v[136:139], v[24:27]
    v_add_u32 v170, 128, v170
    v_mfma_f32_16x16x32_bf16 v[28:31], v[120:123], v[140:143], v[28:31]
    v_add_u32 v171, 128, v171
    v_mfma_f32_16x16x32_bf16 v[32:35], v[120:123], v[144:147], v[32:35]
    v_add_u32 v4, 128, v4
    v_mfma_f32_16x16x32_bf16 v[36:39], v[120:123], v[148:151], v[36:39]
    s_add_u32 s75, s75, 1
    v_mfma_f32_16x16x32_bf16 v[28:31], v[124:127], v[136:139], v[28:31]
    s_cmp_lt_u32 s75, 4
    v_mfma_f32_16x16x32_bf16 v[32:35], v[124:127], v[140:143], v[32:35]
    v_mfma_f32_16x16x32_bf16 v[36:39], v[124:127], v[144:147], v[36:39]
    v_mfma_f32_16x16x32_bf16 v[32:35], v[128:131], v[136:139], v[32:35]
    v_mfma_f32_16x16x32_bf16 v[36:39], v[128:131], v[140:143], v[36:39]
    v_mfma_f32_16x16x32_bf16 v[36:39], v[132:135], v[136:139], v[36:39]
    s_cbranch_scc1 L_conv_loop_f
    s_setprio 3
    s_waitcnt lgkmcnt(0)
    ds_read_b64 v[104:105], v5 offset:3584
    ds_read_b64 v[106:107], v5 offset:3072
    ds_read_b64 v[108:109], v5 offset:2560
    ds_read_b64 v[110:111], v5 offset:2048
    ds_read_b64 v[112:113], v5 offset:1536
    ds_read_b64 v[114:115], v5 offset:1024
    ds_read_b64 v[116:117], v5 offset:512
    ds_read_b64 v[118:119], v5 offset:0
    s_bitcmp1_b32 s82, 0
    s_lshl_b32 s73, s74, 16
    s_and_b32 s74, s74, 0xffff0000
    s_bitcmp1_b32 s82, 0
    s_cselect_b32 s74, s74, s73
    s_waitcnt lgkmcnt(7)
    v_and_b32 v120, 0xffff0000, v105
    v_lshlrev_b32 v121, 16, v105
    v_and_b32 v122, 0xffff0000, v104
    v_lshlrev_b32 v123, 16, v104
    v_fmac_f32 v8, s74, v120
    v_fmac_f32 v9, s74, v121
    v_fmac_f32 v10, s74, v122
    v_fmac_f32 v11, s74, v123
    v_cvt_pk_bf16_f32 v136, v8, v9
    v_cvt_pk_bf16_f32 v137, v10, v11
    s_waitcnt lgkmcnt(6)
    v_and_b32 v124, 0xffff0000, v107
    v_lshlrev_b32 v125, 16, v107
    v_and_b32 v126, 0xffff0000, v106
    v_lshlrev_b32 v127, 16, v106
    v_fmac_f32 v12, s74, v124
    v_fmac_f32 v13, s74, v125
    v_fmac_f32 v14, s74, v126
    v_fmac_f32 v15, s74, v127
    v_cvt_pk_bf16_f32 v138, v12, v13
    v_cvt_pk_bf16_f32 v139, v14, v15
    s_nop 0
    v_permlane16_swap_b32 v136, v138
    v_permlane16_swap_b32 v137, v139
    buffer_store_dwordx4 v[136:139], v6, s[68:71], s72 offen offset:0 sc1
    s_waitcnt lgkmcnt(5)
    v_and_b32 v120, 0xffff0000, v109
    v_lshlrev_b32 v121, 16, v109
    v_and_b32 v122, 0xffff0000, v108
    v_lshlrev_b32 v123, 16, v108
    v_fmac_f32 v16, s74, v120
    v_fmac_f32 v17, s74, v121
    v_fmac_f32 v18, s74, v122
    v_fmac_f32 v19, s74, v123
    v_cvt_pk_bf16_f32 v140, v16, v17
    v_cvt_pk_bf16_f32 v141, v18, v19
    s_waitcnt lgkmcnt(4)
    v_and_b32 v124, 0xffff0000, v111
    v_lshlrev_b32 v125, 16, v111
    v_and_b32 v126, 0xffff0000, v110
    v_lshlrev_b32 v127, 16, v110
    v_fmac_f32 v20, s74, v124
    v_fmac_f32 v21, s74, v125
    v_fmac_f32 v22, s74, v126
    v_fmac_f32 v23, s74, v127
    v_cvt_pk_bf16_f32 v142, v20, v21
    v_cvt_pk_bf16_f32 v143, v22, v23
    s_nop 0
    v_permlane16_swap_b32 v140, v142
    v_permlane16_swap_b32 v141, v143
    buffer_store_dwordx4 v[140:143], v6, s[68:71], s72 offen offset:1024 sc1
    s_waitcnt lgkmcnt(3)
    v_and_b32 v120, 0xffff0000, v113
    v_lshlrev_b32 v121, 16, v113
    v_and_b32 v122, 0xffff0000, v112
    v_lshlrev_b32 v123, 16, v112
    v_fmac_f32 v24, s74, v120
    v_fmac_f32 v25, s74, v121
    v_fmac_f32 v26, s74, v122
    v_fmac_f32 v27, s74, v123
    v_cvt_pk_bf16_f32 v144, v24, v25
    v_cvt_pk_bf16_f32 v145, v26, v27
    s_waitcnt lgkmcnt(2)
    v_and_b32 v124, 0xffff0000, v115
    v_lshlrev_b32 v125, 16, v115
    v_and_b32 v126, 0xffff0000, v114
    v_lshlrev_b32 v127, 16, v114
    v_fmac_f32 v28, s74, v124
    v_fmac_f32 v29, s74, v125
    v_fmac_f32 v30, s74, v126
    v_fmac_f32 v31, s74, v127
    v_cvt_pk_bf16_f32 v146, v28, v29
    v_cvt_pk_bf16_f32 v147, v30, v31
    s_nop 0
    v_permlane16_swap_b32 v144, v146
    v_permlane16_swap_b32 v145, v147
    buffer_store_dwordx4 v[144:147], v6, s[68:71], s72 offen offset:2048 sc1
    s_waitcnt lgkmcnt(1)
    v_and_b32 v120, 0xffff0000, v117
    v_lshlrev_b32 v121, 16, v117
    v_and_b32 v122, 0xffff0000, v116
    v_lshlrev_b32 v123, 16, v116
    v_fmac_f32 v32, s74, v120
    v_fmac_f32 v33, s74, v121
    v_fmac_f32 v34, s74, v122
    v_fmac_f32 v35, s74, v123
    v_cvt_pk_bf16_f32 v148, v32, v33
    v_cvt_pk_bf16_f32 v149, v34, v35
    s_waitcnt lgkmcnt(0)
    v_and_b32 v124, 0xffff0000, v119
    v_lshlrev_b32 v125, 16, v119
    v_and_b32 v126, 0xffff0000, v118
    v_lshlrev_b32 v127, 16, v118
    v_fmac_f32 v36, s74, v124
    v_fmac_f32 v37, s74, v125
    v_fmac_f32 v38, s74, v126
    v_fmac_f32 v39, s74, v127
    v_cvt_pk_bf16_f32 v150, v36, v37
    v_cvt_pk_bf16_f32 v151, v38, v39
    s_nop 0
    v_permlane16_swap_b32 v148, v150
    v_permlane16_swap_b32 v149, v151
    buffer_store_dwordx4 v[148:151], v6, s[68:71], s72 offen offset:3072 sc1
    s_lshl_b32 s10, s82, 3
    s_add_u32 s83, s10, 208896
    s_waitcnt vmcnt(0)
    v_mov_b32 v4, s90
    v_mov_b32 v5, s91
    v_mov_b32 v6, 0
    s_mov_b64 exec, 1
    buffer_store_dwordx2 v[4:5], v6, s[92:95], s83 offen sc1
    s_mov_b64 exec, -1
L_b_aprep:
    s_setprio 1
    s_mov_b32 s40, s16
    s_mov_b32 s41, s17
    s_mov_b32 s42, 0x280000
    s_mov_b32 s43, 0x20000
    s_add_u32 s44, s38, 0x1000000
    s_addc_u32 s45, s39, 0
    s_mov_b32 s46, 0x4000
    s_mov_b32 s47, 0x20000
    s_add_u32 s68, s38, 0xd00000
    s_addc_u32 s69, s39, 0
    s_mov_b32 s70, 0x294000
    s_mov_b32 s71, 0x20000
    s_lshl_b32 s53, s8, 2
    s_add_u32 s53, s53, s101
    s_mul_i32 s54, s53, 20480
    s_mul_i32 s55, s9, 160
    s_add_u32 s54, s54, s55
    v_add_u32 v1, 0, v0
    v_mul_u32_u24 v2, 6554, v1
    v_lshrrev_b32 v2, 16, v2
    v_mul_u32_u24 v2, 1120, v2
    v_lshl_add_u32 v8, v1, 4, v2
    v_add_u32 v1, 64, v0
    v_mul_u32_u24 v2, 6554, v1
    v_lshrrev_b32 v2, 16, v2
    v_mul_u32_u24 v2, 1120, v2
    v_lshl_add_u32 v9, v1, 4, v2
    v_add_u32 v1, 128, v0
    v_mul_u32_u24 v2, 6554, v1
    v_lshrrev_b32 v2, 16, v2
    v_mul_u32_u24 v2, 1120, v2
    v_lshl_add_u32 v10, v1, 4, v2
    v_mov_b32 v2, 1073741824
    v_cmp_gt_u32 vcc, 32, v0
    s_nop 1
    v_cndmask_b32 v10, v2, v10, vcc
    s_add_u32 m0, s81, 0
    s_nop 0
    buffer_load_dwordx4 v8, s[40:43], s54 offen lds
    s_add_u32 m0, s81, 1024
    s_nop 0
    buffer_load_dwordx4 v9, s[40:43], s54 offen lds
    s_add_u32 m0, s81, 2048
    s_nop 0
    buffer_load_dwordx4 v10, s[40:43], s54 offen lds
    v_and_b32 v1, 15, v0
    v_lshlrev_b32 v3, 3, v1
    s_lshl_b32 s57, s53, 7
    v_lshrrev_b32 v4, 3, v0
    v_mul_u32_u24 v4, 4224, v4
    v_and_b32 v2, 7, v0
    v_lshl_add_u32 v4, v2, 4, v4
    s_mul_i32 s58, s9, 10
    s_add_u32 s58, s58, s101
    s_mul_i32 s58, s58, 33792
    s_lshl_b32 s59, s8, 7
    s_add_u32 s58, s58, s59
    v_mov_b32 v2, 163776
    v_mul_u32_u24 v5, 160, v1
    v_lshrrev_b32 v6, 4, v0
    v_lshl_add_u32 v5, v6, 3, v5
    v_add_u32 v5, s81, v5
    v_lshrrev_b32 v36, 5, v0
    v_mul_u32_u24 v36, 21248, v36
    v_bfe_u32 v7, v0, 2, 3
    v_lshl_add_u32 v36, v7, 7, v36
    v_and_b32 v7, 3, v0
    v_lshl_add_u32 v36, v7, 3, v36
    s_lshl_b32 s59, s101, 5
    s_add_u32 s59, s59, 65536
    v_add_u32 v36, s59, v36
    v_lshlrev_b32 v37, 4, v0
    v_add_u32 v37, s81, v37
    s_waitcnt vmcnt(0)
    ds_read_b64 v[16:17], v5 offset:0
    ds_read_b64 v[18:19], v5 offset:32
    ds_read_b64 v[20:21], v5 offset:64
    ds_read_b64 v[22:23], v5 offset:96
    ds_read_b64 v[24:25], v5 offset:128
    s_waitcnt lgkmcnt(0)
    v_lshlrev_b32 v40, 16, v16
    v_and_b32 v41, 0xffff0000, v16
    v_lshlrev_b32 v42, 16, v17
    v_and_b32 v43, 0xffff0000, v17
    ds_write_b128 v37, v[40:43] offset:11264
    v_lshlrev_b32 v44, 16, v18
    v_and_b32 v45, 0xffff0000, v18
    v_lshlrev_b32 v46, 16, v19
    v_and_b32 v47, 0xffff0000, v19
    ds_write_b128 v37, v[44:47] offset:12288
    v_lshlrev_b32 v48, 16, v20
    v_and_b32 v49, 0xffff0000, v20
    v_lshlrev_b32 v50, 16, v21
    v_and_b32 v51, 0xffff0000, v21
    ds_write_b128 v37, v[48:51] offset:13312
    v_lshlrev_b32 v52, 16, v22
    v_and_b32 v53, 0xffff0000, v22
    v_lshlrev_b32 v54, 16, v23
    v_and_b32 v55, 0xffff0000, v23
    v_lshlrev_b32 v56, 16, v24
    v_and_b32 v57, 0xffff0000, v24
    v_lshlrev_b32 v58, 16, v25
    v_and_b32 v59, 0xffff0000, v25
    s_setprio 0
    s_cmp_eq_u32 s101, 0
    s_cbranch_scc1 L_b_poller
L_b_lw0:
    ds_read_b32 v6, v2 offset:20
    s_waitcnt lgkmcnt(0)
    v_readfirstlane_b32 s60, v6
    s_nop 0
    s_cmp_lg_u32 s60, 0
    s_cbranch_scc1 L_b_lw0_ok
    s_sleep 16
    s_branch L_b_lw0
L_b_lw0_ok:
L_b_lwait:
    ds_read_b32 v6, v2 offset:4
    s_waitcnt lgkmcnt(0)
    v_readfirstlane_b32 s60, v6
    s_nop 0
    s_cmp_lg_u32 s60, 0
    s_cbranch_scc1 L_b_lwait_ok
    s_sleep 2
    s_branch L_b_lwait
L_b_lwait_ok:
    s_setprio 3
    s_branch L_b_go
L_b_poller:
    s_mul_i32 s59, s9, 640
    s_add_u32 s59, s59, 208896
    s_add_u32 s61, s59, 512
    v_lshlrev_b32 v5, 3, v0
    v_add_u32 v7, s61, v5
    s_lshr_b32 s10, s8, 3
    s_lshl_b32 s10, s10, 1
    s_and_b32 s11, s8, 1
    s_add_u32 s10, s10, s11
    s_and_b32 s11, s8, 6
    s_lshl_b32 s11, s11, 2
    s_add_u32 s10, s10, s11
    s_add_u32 s10, s10, 576
    s_lshl_b32 s10, s10, 7
    v_writelane_b32 v7, s10, 16
L_b_aw:
    ds_read_b32 v6, v2 offset:20
    s_waitcnt lgkmcnt(0)
    v_readfirstlane_b32 s60, v6
    s_nop 0
    s_cmp_lg_u32 s60, 0
    s_cbranch_scc1 L_b_aw_ok
    s_sleep 6
    s_branch L_b_aw
L_b_aw_ok:
    s_setprio 3
    s_bfm_b64 exec, 17, 0
    buffer_load_dwordx2 v[14:15], v7, s[92:95], 0 offen sc1
    s_mov_b64 exec, -1
    s_mov_b32 s60, 0
L_by:
    buffer_load_dwordx2 v[12:13], v5, s[92:95], s59 offen sc1
    s_waitcnt vmcnt(0)
L_by_chk:
    v_cmp_ne_u64 vcc, s[90:91], v[12:13]
    s_nop 0
    s_and_b64 exec, exec, vcc
    s_cbranch_scc0 L_by_ok
    s_sleep 8
    s_add_u32 s60, s60, 1
    s_cmp_lt_u32 s60, 0x20000
    s_cbranch_scc1 L_by
L_by_ok:
    s_mov_b64 exec, -1
    s_mov_b32 s60, 0
    s_bfm_b64 exec, 17, 0
    s_branch L_by2_chk
L_by2:
    buffer_load_dwordx2 v[14:15], v7, s[92:95], 0 offen sc1
    s_waitcnt vmcnt(0)
L_by2_chk:
    v_cmp_ne_u64 vcc, s[90:91], v[14:15]
    s_nop 0
    s_and_b64 exec, exec, vcc
    s_cbranch_scc0 L_by2_ok
    s_sleep 8
    s_add_u32 s60, s60, 1
    s_cmp_lt_u32 s60, 0x20000
    s_cbranch_scc1 L_by2
L_by2_ok:
    s_mov_b64 exec, -1
    v_mov_b32 v6, 1
    ds_write_b32 v2, v6 offset:4
L_b_go:
    buffer_load_dwordx2 v[12:13], v3, s[44:47], s57 offen sc1
    s_add_u32 m0, s81, 3072
    s_nop 0
    buffer_load_dwordx4 v4, s[68:71], s58 offen sc1 lds
    s_add_u32 s58, s58, 135168
    s_add_u32 m0, s81, 4096
    s_nop 0
    buffer_load_dwordx4 v4, s[68:71], s58 offen sc1 lds
    s_add_u32 s58, s58, 135168
    s_cmp_ge_u32 s101, 2
    s_cbranch_scc1 L_b_noy
    s_add_u32 m0, s81, 5120
    s_nop 0
    buffer_load_dwordx4 v4, s[68:71], s58 offen sc1 lds
L_b_noy:
    v_mov_b32 v3, 1
    s_waitcnt vmcnt(2)
    v_mul_f32 v38, 0xbfb8aa3b, v13
    v_mul_f32 v39, 0xbfb8aa3b, v13
    ds_write_b64 v37, v[38:39] offset:16384
    v_sub_f32 v80, v40, v12
    v_sub_f32 v81, v41, v12
    v_cvt_pk_bf16_f32 v81, v80, v81
    v_lshlrev_b32 v80, 16, v81
    v_and_b32 v81, 0xffff0000, v81
    v_mul_f32 v80, v80, v13
    v_mul_f32 v81, v81, v13
    v_cvt_pk_bf16_f32 v81, v80, v81
    v_lshlrev_b32 v80, 16, v81
    v_and_b32 v81, 0xffff0000, v81
    v_mul_f32 v80, v80, v13
    v_mul_f32 v81, v81, v13
    v_sub_f32 v82, v42, v12
    v_sub_f32 v83, v43, v12
    v_cvt_pk_bf16_f32 v83, v82, v83
    v_lshlrev_b32 v82, 16, v83
    v_and_b32 v83, 0xffff0000, v83
    v_mul_f32 v82, v82, v13
    v_mul_f32 v83, v83, v13
    v_cvt_pk_bf16_f32 v83, v82, v83
    v_lshlrev_b32 v82, 16, v83
    v_and_b32 v83, 0xffff0000, v83
    v_mul_f32 v82, v82, v13
    v_mul_f32 v83, v83, v13
    v_sub_f32 v84, v44, v12
    v_sub_f32 v85, v45, v12
    v_cvt_pk_bf16_f32 v85, v84, v85
    v_lshlrev_b32 v84, 16, v85
    v_and_b32 v85, 0xffff0000, v85
    v_mul_f32 v84, v84, v13
    v_mul_f32 v85, v85, v13
    v_cvt_pk_bf16_f32 v85, v84, v85
    v_lshlrev_b32 v84, 16, v85
    v_and_b32 v85, 0xffff0000, v85
    v_mul_f32 v84, v84, v13
    v_mul_f32 v85, v85, v13
    v_sub_f32 v86, v46, v12
    v_sub_f32 v87, v47, v12
    v_cvt_pk_bf16_f32 v87, v86, v87
    v_lshlrev_b32 v86, 16, v87
    v_and_b32 v87, 0xffff0000, v87
    v_mul_f32 v86, v86, v13
    v_mul_f32 v87, v87, v13
    v_cvt_pk_bf16_f32 v87, v86, v87
    v_lshlrev_b32 v86, 16, v87
    v_and_b32 v87, 0xffff0000, v87
    v_mul_f32 v86, v86, v13
    v_mul_f32 v87, v87, v13
    v_sub_f32 v88, v48, v12
    v_sub_f32 v89, v49, v12
    v_cvt_pk_bf16_f32 v89, v88, v89
    v_lshlrev_b32 v88, 16, v89
    v_and_b32 v89, 0xffff0000, v89
    v_mul_f32 v88, v88, v13
    v_mul_f32 v89, v89, v13
    v_cvt_pk_bf16_f32 v89, v88, v89
    v_lshlrev_b32 v88, 16, v89
    v_and_b32 v89, 0xffff0000, v89
    v_mul_f32 v88, v88, v13
    v_mul_f32 v89, v89, v13
    s_waitcnt vmcnt(0)
    s_mov_b64 exec, 1
    ds_add_u32 v2, v3 offset:0
    s_mov_b64 exec, -1
    v_sub_f32 v90, v50, v12
    v_sub_f32 v91, v51, v12
    v_cvt_pk_bf16_f32 v91, v90, v91
    v_lshlrev_b32 v90, 16, v91
    v_and_b32 v91, 0xffff0000, v91
    v_mul_f32 v90, v90, v13
    v_mul_f32 v91, v91, v13
    v_cvt_pk_bf16_f32 v91, v90, v91
    v_lshlrev_b32 v90, 16, v91
    v_and_b32 v91, 0xffff0000, v91
    v_mul_f32 v90, v90, v13
    v_mul_f32 v91, v91, v13
    v_sub_f32 v92, v52, v12
    v_sub_f32 v93, v53, v12
    v_cvt_pk_bf16_f32 v93, v92, v93
    v_lshlrev_b32 v92, 16, v93
    v_and_b32 v93, 0xffff0000, v93
    v_mul_f32 v92, v92, v13
    v_mul_f32 v93, v93, v13
    v_cvt_pk_bf16_f32 v93, v92, v93
    v_lshlrev_b32 v92, 16, v93
    v_and_b32 v93, 0xffff0000, v93
    v_mul_f32 v92, v92, v13
    v_mul_f32 v93, v93, v13
    v_sub_f32 v94, v54, v12
    v_sub_f32 v95, v55, v12
    v_cvt_pk_bf16_f32 v95, v94, v95
    v_lshlrev_b32 v94, 16, v95
    v_and_b32 v95, 0xffff0000, v95
    v_mul_f32 v94, v94, v13
    v_mul_f32 v95, v95, v13
    v_cvt_pk_bf16_f32 v95, v94, v95
    v_lshlrev_b32 v94, 16, v95
    v_and_b32 v95, 0xffff0000, v95
    v_mul_f32 v94, v94, v13
    v_mul_f32 v95, v95, v13
    v_sub_f32 v96, v56, v12
    v_sub_f32 v97, v57, v12
    v_cvt_pk_bf16_f32 v97, v96, v97
    v_lshlrev_b32 v96, 16, v97
    v_and_b32 v97, 0xffff0000, v97
    v_mul_f32 v96, v96, v13
    v_mul_f32 v97, v97, v13
    v_cvt_pk_bf16_f32 v97, v96, v97
    v_lshlrev_b32 v96, 16, v97
    v_and_b32 v97, 0xffff0000, v97
    v_mul_f32 v96, v96, v13
    v_mul_f32 v97, v97, v13
    v_sub_f32 v98, v58, v12
    v_sub_f32 v99, v59, v12
    v_cvt_pk_bf16_f32 v99, v98, v99
    v_lshlrev_b32 v98, 16, v99
    v_and_b32 v99, 0xffff0000, v99
    v_mul_f32 v98, v98, v13
    v_mul_f32 v99, v99, v13
    v_cvt_pk_bf16_f32 v99, v98, v99
    v_lshlrev_b32 v98, 16, v99
    v_and_b32 v99, 0xffff0000, v99
    v_mul_f32 v98, v98, v13
    v_mul_f32 v99, v99, v13
L_b_cnt:
    ds_read_b32 v3, v2 offset:0
    ds_read_b64_tr_b16 v[26:27], v36 offset:3072
    ds_read_b64_tr_b16 v[28:29], v36 offset:45568
    ds_read_b64_tr_b16 v[30:31], v36 offset:4096
    ds_read_b64_tr_b16 v[32:33], v36 offset:46592
    ds_read_b64_tr_b16 v[34:35], v36 offset:5120
    s_waitcnt lgkmcnt(0)
    v_readfirstlane_b32 s59, v3
    s_nop 0
    s_cmp_lt_u32 s59, 4
    s_cbranch_scc1 L_b_cnt
    v_lshlrev_b32 v60, 16, v26
    v_and_b32 v61, 0xffff0000, v26
    v_mul_f32 v60, v60, v80
    v_mul_f32 v61, v61, v81
    v_lshlrev_b32 v62, 16, v27
    v_and_b32 v63, 0xffff0000, v27
    v_mul_f32 v62, v62, v82
    v_mul_f32 v63, v63, v83
    ds_write_b128 v37, v[60:63] offset:6144
    v_lshlrev_b32 v64, 16, v28
    v_and_b32 v65, 0xffff0000, v28
    v_mul_f32 v64, v64, v84
    v_mul_f32 v65, v65, v85
    v_lshlrev_b32 v66, 16, v29
    v_and_b32 v67, 0xffff0000, v29
    v_mul_f32 v66, v66, v86
    v_mul_f32 v67, v67, v87
    ds_write_b128 v37, v[64:67] offset:7168
    v_lshlrev_b32 v68, 16, v30
    v_and_b32 v69, 0xffff0000, v30
    v_mul_f32 v68, v68, v88
    v_mul_f32 v69, v69, v89
    v_lshlrev_b32 v70, 16, v31
    v_and_b32 v71, 0xffff0000, v31
    v_mul_f32 v70, v70, v90
    v_mul_f32 v71, v71, v91
    ds_write_b128 v37, v[68:71] offset:8192
    v_lshlrev_b32 v72, 16, v32
    v_and_b32 v73, 0xffff0000, v32
    v_mul_f32 v72, v72, v92
    v_mul_f32 v73, v73, v93
    v_lshlrev_b32 v74, 16, v33
    v_and_b32 v75, 0xffff0000, v33
    v_mul_f32 v74, v74, v94
    v_mul_f32 v75, v75, v95
    v_lshlrev_b32 v76, 16, v34
    v_and_b32 v77, 0xffff0000, v34
    v_mul_f32 v76, v76, v96
    v_mul_f32 v77, v77, v97
    v_lshlrev_b32 v78, 16, v35
    v_and_b32 v79, 0xffff0000, v35
    v_mul_f32 v78, v78, v98
    v_mul_f32 v79, v79, v99
    s_mov_b32 s48, s34
    s_mov_b32 s49, s35
    s_mov_b32 s50, 0x280000
    s_mov_b32 s51, 0x20000
    v_lshlrev_b32 v8, 4, v0
    s_lshl_b32 s59, s101, 14
    v_add_u32 v8, s59, v8
    v_xor_b32 v9, 16384, v8
    v_xor_b32 v10, 32768, v8
    v_xor_b32 v11, 49152, v8
    v_and_b32 v12, 15, v0
    v_lshlrev_b32 v12, 6, v12
    v_lshrrev_b32 v13, 4, v0
    v_lshl_add_u32 v12, v13, 3, v12
    v_add_u32 v12, s81, v12
    v_lshrrev_b32 v13, 2, v0
    v_mul_u32_u24 v13, 1280, v13
    v_and_b32 v14, 3, v0
    v_lshl_add_u32 v13, v14, 4, v13
    v_mov_b32 v14, 1.0
    v_mov_b32 v15, 1.0
    s_waitcnt lgkmcnt(0)
    s_barrier
    ds_read_b128 v[104:107], v37 offset:9216
    ds_read_b128 v[108:111], v9 offset:3072
    ds_read_b128 v[112:115], v10 offset:8192
    ds_read_b128 v[116:119], v11 offset:13312
    ds_read_b128 v[120:123], v37 offset:10240
    ds_read_b128 v[124:127], v9 offset:4096
    ds_read_b128 v[128:131], v10 offset:9216
    ds_read_b128 v[132:135], v11 offset:14336
    s_waitcnt lgkmcnt(4)
    v_pk_add_f32 v[104:105], v[104:105], v[108:109]
    v_pk_add_f32 v[112:113], v[112:113], v[116:117]
    v_pk_add_f32 v[106:107], v[106:107], v[110:111]
    v_pk_add_f32 v[114:115], v[114:115], v[118:119]
    v_pk_add_f32 v[104:105], v[104:105], v[112:113]
    v_pk_add_f32 v[106:107], v[106:107], v[114:115]
    v_pk_mul_f32 v[108:109], v[104:105], v[38:39]
    v_pk_mul_f32 v[110:111], v[106:107], v[38:39]
    v_exp_f32 v108, v108
    v_exp_f32 v109, v109
    v_exp_f32 v110, v110
    v_exp_f32 v111, v111
    v_pk_mul_f32 v[104:105], v[104:105], v[72:73]
    v_pk_mul_f32 v[106:107], v[106:107], v[74:75]
    v_pk_add_f32 v[108:109], v[108:109], v[14:15]
    v_pk_add_f32 v[110:111], v[110:111], v[14:15]
    v_rcp_f32 v108, v108
    v_rcp_f32 v109, v109
    v_rcp_f32 v110, v110
    v_rcp_f32 v111, v111
    v_pk_fma_f32 v[104:105], v[104:105], v[108:109], v[52:53]
    v_pk_fma_f32 v[106:107], v[106:107], v[110:111], v[54:55]
    v_cvt_pk_bf16_f32 v112, v104, v105
    v_cvt_pk_bf16_f32 v113, v106, v107
    s_waitcnt lgkmcnt(0)
    v_pk_add_f32 v[120:121], v[120:121], v[124:125]
    v_pk_add_f32 v[128:129], v[128:129], v[132:133]
    v_pk_add_f32 v[122:123], v[122:123], v[126:127]
    v_pk_add_f32 v[130:131], v[130:131], v[134:135]
    v_pk_add_f32 v[120:121], v[120:121], v[128:129]
    v_pk_add_f32 v[122:123], v[122:123], v[130:131]
    v_pk_mul_f32 v[124:125], v[120:121], v[38:39]
    v_pk_mul_f32 v[126:127], v[122:123], v[38:39]
    v_exp_f32 v124, v124
    v_exp_f32 v125, v125
    v_exp_f32 v126, v126
    v_exp_f32 v127, v127
    v_pk_mul_f32 v[120:121], v[120:121], v[76:77]
    v_pk_mul_f32 v[122:123], v[122:123], v[78:79]
    v_pk_add_f32 v[124:125], v[124:125], v[14:15]
    v_pk_add_f32 v[126:127], v[126:127], v[14:15]
    v_rcp_f32 v124, v124
    v_rcp_f32 v125, v125
    v_rcp_f32 v126, v126
    v_rcp_f32 v127, v127
    v_pk_fma_f32 v[120:121], v[120:121], v[124:125], v[56:57]
    v_pk_fma_f32 v[122:123], v[122:123], v[126:127], v[58:59]
    v_cvt_pk_bf16_f32 v128, v120, v121
    v_cvt_pk_bf16_f32 v129, v122, v123
    ds_write_b64 v12, v[112:113] offset:3072
    ds_write_b64 v12, v[128:129] offset:3104
    s_waitcnt lgkmcnt(0)
    ds_read_b128 v[16:19], v37 offset:3072
    s_waitcnt lgkmcnt(0)
    buffer_store_dwordx4 v[16:19], v13, s[48:51], s54 offen offset:96
    s_endpgm
L_free:
    s_waitcnt lgkmcnt(0)
    s_add_u32 s92, s38, 0x1010000
    s_addc_u32 s93, s39, 0
    s_mov_b32 s94, 0x47800
    s_mov_b32 s95, 0x20000
    s_load_dwordx2 s[90:91], s[92:93], 40960
    s_sub_u32 s84, s2, 224
    s_mov_b32 s85, s3
    s_cmp_eq_u32 s3, 7
    s_cbranch_scc1 L_free_code
    s_cmp_lt_u32 s3, 4
    s_cbranch_scc1 L_free_stats
    s_setprio 2
    s_mul_i32 s85, s84, 3
    s_add_u32 s85, s85, s101
    s_add_u32 s85, s85, 224
    s_mov_b32 s40, s18
    s_mov_b32 s41, s19
    s_mov_b32 s42, 0x280000
    s_mov_b32 s43, 0x20000
    s_mov_b32 s44, s20
    s_mov_b32 s45, s21
    s_mov_b32 s46, 0x280000
    s_mov_b32 s47, 0x20000
    s_mov_b32 s52, s22
    s_mov_b32 s53, s23
    s_mov_b32 s54, 0x1400
    s_mov_b32 s55, 0x20000
    s_add_u32 s56, s38, 0xa00000
    s_addc_u32 s57, s39, 0
    s_mov_b32 s58, 0x294000
    s_mov_b32 s59, 0x20000
    s_mul_i32 s48, s85, 6554
    s_lshr_b32 s48, s48, 16
    s_mul_i32 s49, s48, 10
    s_sub_u32 s49, s85, s49
    v_and_b32 v1, 7, v0
    v_lshrrev_b32 v2, 3, v0
    s_mul_i32 s51, s48, 81920
    s_lshl_b32 s60, s49, 7
    s_add_u32 s51, s51, s60
    v_mul_u32_u24 v4, 10240, v2
    v_lshl_add_u32 v4, v1, 4, v4
    v_add_u32 v4, s51, v4
    v_subrev_u32 v5, 3840, v4
    s_movk_i32 s61, 5120
    v_lshlrev_b32 v3, 4, v0
    s_lshl_b32 s50, s49, 9
    s_mov_b32 m0, s81
    s_nop 0
    buffer_load_dwordx4 v3, s[52:55], s50 offen lds
    buffer_load_dwordx4 v[56:59], v4, s[40:43], s61 offen offset:1280
    buffer_load_dwordx4 v[24:27], v5, s[40:43], 0 offen offset:0
    buffer_load_dwordx4 v[60:63], v4, s[40:43], s61 offen offset:2560
    buffer_load_dwordx4 v[28:31], v5, s[40:43], 0 offen offset:1280
    buffer_load_dwordx4 v[64:67], v4, s[40:43], s61 offen offset:3840
    buffer_load_dwordx4 v[32:35], v5, s[40:43], 0 offen offset:2560
    buffer_load_dwordx4 v[36:39], v4, s[40:43], 0 offen offset:0
    buffer_load_dwordx4 v[68:71], v4, s[44:47], 0 offen offset:0
    buffer_load_dwordx4 v[40:43], v4, s[40:43], 0 offen offset:1280
    buffer_load_dwordx4 v[72:75], v4, s[44:47], 0 offen offset:1280
    buffer_load_dwordx4 v[44:47], v4, s[40:43], 0 offen offset:2560
    buffer_load_dwordx4 v[76:79], v4, s[44:47], 0 offen offset:2560
    buffer_load_dwordx4 v[48:51], v4, s[40:43], 0 offen offset:3840
    buffer_load_dwordx4 v[80:83], v4, s[44:47], 0 offen offset:3840
    buffer_load_dwordx4 v[52:55], v4, s[40:43], s61 offen offset:0
    buffer_load_dwordx4 v[84:87], v4, s[44:47], s61 offen offset:0
    buffer_load_dwordx4 v[88:91], v4, s[44:47], s61 offen offset:1280
    buffer_load_dwordx4 v[92:95], v4, s[44:47], s61 offen offset:2560
    buffer_load_dwordx4 v[96:99], v4, s[44:47], s61 offen offset:3840
    v_lshl_add_u32 v6, v1, 6, s81
    s_waitcnt vmcnt(19)
    ds_read_b128 v[8:11], v6 offset:0
    ds_read_b128 v[12:15], v6 offset:16
    ds_read_b128 v[16:19], v6 offset:32
    ds_read_b128 v[20:23], v6 offset:48
    v_sub_u32 v7, 7, v2
    v_xor_b32 v7, v7, v1
    v_lshlrev_b32 v7, 4, v7
    v_lshl_add_u32 v7, v1, 10, v7
    v_add_u32 v7, s81, v7
    v_xor_b32 v6, v1, v2
    v_lshlrev_b32 v6, 4, v6
    v_lshl_add_u32 v6, v2, 10, v6
    v_add_u32 v6, s81, v6
    v_mul_u32_u24 v3, 33792, v2
    v_lshl_add_u32 v3, v1, 4, v3
    s_waitcnt lgkmcnt(0)
    v_lshlrev_b32 v100, 16, v8
    v_and_b32 v108, 0xffff0000, v8
    v_lshlrev_b32 v116, 16, v9
    v_and_b32 v124, 0xffff0000, v9
    v_lshlrev_b32 v101, 16, v10
    v_and_b32 v109, 0xffff0000, v10
    v_lshlrev_b32 v117, 16, v11
    v_and_b32 v125, 0xffff0000, v11
    v_lshlrev_b32 v102, 16, v12
    v_and_b32 v110, 0xffff0000, v12
    v_lshlrev_b32 v118, 16, v13
    v_and_b32 v126, 0xffff0000, v13
    v_lshlrev_b32 v103, 16, v14
    v_and_b32 v111, 0xffff0000, v14
    v_lshlrev_b32 v119, 16, v15
    v_and_b32 v127, 0xffff0000, v15
    v_lshlrev_b32 v104, 16, v16
    v_and_b32 v112, 0xffff0000, v16
    v_lshlrev_b32 v120, 16, v17
    v_and_b32 v128, 0xffff0000, v17
    v_lshlrev_b32 v105, 16, v18
    v_and_b32 v113, 0xffff0000, v18
    v_lshlrev_b32 v121, 16, v19
    v_and_b32 v129, 0xffff0000, v19
    v_lshlrev_b32 v106, 16, v20
    v_and_b32 v114, 0xffff0000, v20
    v_lshlrev_b32 v122, 16, v21
    v_and_b32 v130, 0xffff0000, v21
    v_lshlrev_b32 v107, 16, v22
    v_and_b32 v115, 0xffff0000, v22
    v_lshlrev_b32 v123, 16, v23
    v_and_b32 v131, 0xffff0000, v23
    s_waitcnt vmcnt(13)
    v_lshlrev_b32 v132, 16, v24
    v_and_b32 v133, 0xffff0000, v24
    v_lshlrev_b32 v134, 16, v25
    v_and_b32 v135, 0xffff0000, v25
    v_lshlrev_b32 v136, 16, v26
    v_and_b32 v137, 0xffff0000, v26
    v_lshlrev_b32 v138, 16, v27
    v_and_b32 v139, 0xffff0000, v27
    v_lshlrev_b32 v140, 16, v28
    v_and_b32 v141, 0xffff0000, v28
    v_lshlrev_b32 v142, 16, v29
    v_and_b32 v143, 0xffff0000, v29
    v_lshlrev_b32 v144, 16, v30
    v_and_b32 v145, 0xffff0000, v30
    v_lshlrev_b32 v146, 16, v31
    v_and_b32 v147, 0xffff0000, v31
    v_lshlrev_b32 v148, 16, v32
    v_and_b32 v149, 0xffff0000, v32
    v_lshlrev_b32 v150, 16, v33
    v_and_b32 v151, 0xffff0000, v33
    v_lshlrev_b32 v152, 16, v34
    v_and_b32 v153, 0xffff0000, v34
    v_lshlrev_b32 v154, 16, v35
    v_and_b32 v155, 0xffff0000, v35
    s_waitcnt vmcnt(11)
    v_lshlrev_b32 v156, 16, v36
    v_and_b32 v157, 0xffff0000, v36
    v_lshlrev_b32 v158, 16, v37
    v_and_b32 v159, 0xffff0000, v37
    v_lshlrev_b32 v160, 16, v38
    v_and_b32 v161, 0xffff0000, v38
    v_lshlrev_b32 v162, 16, v39
    v_and_b32 v163, 0xffff0000, v39
    v_lshlrev_b32 v164, 16, v68
    v_and_b32 v165, 0xffff0000, v68
    v_lshlrev_b32 v166, 16, v69
    v_and_b32 v167, 0xffff0000, v69
    v_lshlrev_b32 v168, 16, v70
    v_and_b32 v169, 0xffff0000, v70
    v_lshlrev_b32 v170, 16, v71
    v_and_b32 v171, 0xffff0000, v71
    v_pk_mul_f32 v[172:173], v[132:133], v[124:125]
    v_pk_fma_f32 v[172:173], v[140:141], v[116:117], v[172:173]
    v_pk_fma_f32 v[172:173], v[148:149], v[108:109], v[172:173]
    v_pk_fma_f32 v[172:173], v[156:157], v[100:101], v[172:173]
    v_pk_mul_f32 v[174:175], v[134:135], v[126:127]
    v_pk_fma_f32 v[174:175], v[142:143], v[118:119], v[174:175]
    v_pk_fma_f32 v[174:175], v[150:151], v[110:111], v[174:175]
    v_pk_fma_f32 v[174:175], v[158:159], v[102:103], v[174:175]
    v_pk_mul_f32 v[176:177], v[136:137], v[128:129]
    v_pk_fma_f32 v[176:177], v[144:145], v[120:121], v[176:177]
    v_pk_fma_f32 v[176:177], v[152:153], v[112:113], v[176:177]
    v_pk_fma_f32 v[176:177], v[160:161], v[104:105], v[176:177]
    v_pk_mul_f32 v[178:179], v[138:139], v[130:131]
    v_pk_fma_f32 v[178:179], v[146:147], v[122:123], v[178:179]
    v_pk_fma_f32 v[178:179], v[154:155], v[114:115], v[178:179]
    v_pk_fma_f32 v[178:179], v[162:163], v[106:107], v[178:179]
    v_pk_mul_f32 v[172:173], v[172:173], v[164:165]
    v_pk_mul_f32 v[174:175], v[174:175], v[166:167]
    v_pk_mul_f32 v[176:177], v[176:177], v[168:169]
    v_pk_mul_f32 v[178:179], v[178:179], v[170:171]
    s_waitcnt vmcnt(9)
    v_lshlrev_b32 v132, 16, v40
    v_and_b32 v133, 0xffff0000, v40
    v_lshlrev_b32 v134, 16, v41
    v_and_b32 v135, 0xffff0000, v41
    v_lshlrev_b32 v136, 16, v42
    v_and_b32 v137, 0xffff0000, v42
    v_lshlrev_b32 v138, 16, v43
    v_and_b32 v139, 0xffff0000, v43
    v_lshlrev_b32 v164, 16, v72
    v_and_b32 v165, 0xffff0000, v72
    v_lshlrev_b32 v166, 16, v73
    v_and_b32 v167, 0xffff0000, v73
    v_lshlrev_b32 v168, 16, v74
    v_and_b32 v169, 0xffff0000, v74
    v_lshlrev_b32 v170, 16, v75
    v_and_b32 v171, 0xffff0000, v75
    v_pk_mul_f32 v[180:181], v[140:141], v[124:125]
    v_pk_fma_f32 v[180:181], v[148:149], v[116:117], v[180:181]
    v_pk_fma_f32 v[180:181], v[156:157], v[108:109], v[180:181]
    v_pk_fma_f32 v[180:181], v[132:133], v[100:101], v[180:181]
    v_pk_mul_f32 v[182:183], v[142:143], v[126:127]
    v_pk_fma_f32 v[182:183], v[150:151], v[118:119], v[182:183]
    v_pk_fma_f32 v[182:183], v[158:159], v[110:111], v[182:183]
    v_pk_fma_f32 v[182:183], v[134:135], v[102:103], v[182:183]
    v_pk_mul_f32 v[184:185], v[144:145], v[128:129]
    v_pk_fma_f32 v[184:185], v[152:153], v[120:121], v[184:185]
    v_pk_fma_f32 v[184:185], v[160:161], v[112:113], v[184:185]
    v_pk_fma_f32 v[184:185], v[136:137], v[104:105], v[184:185]
    v_pk_mul_f32 v[186:187], v[146:147], v[130:131]
    v_pk_fma_f32 v[186:187], v[154:155], v[122:123], v[186:187]
    v_pk_fma_f32 v[186:187], v[162:163], v[114:115], v[186:187]
    v_pk_fma_f32 v[186:187], v[138:139], v[106:107], v[186:187]
    v_pk_mul_f32 v[180:181], v[180:181], v[164:165]
    v_pk_mul_f32 v[182:183], v[182:183], v[166:167]
    v_pk_mul_f32 v[184:185], v[184:185], v[168:169]
    v_pk_mul_f32 v[186:187], v[186:187], v[170:171]
    v_cvt_pk_bf16_f32 v191, v180, v172
    v_cvt_pk_bf16_f32 v195, v181, v173
    v_cvt_pk_bf16_f32 v199, v182, v174
    v_cvt_pk_bf16_f32 v203, v183, v175
    v_cvt_pk_bf16_f32 v207, v184, v176
    v_cvt_pk_bf16_f32 v211, v185, v177
    v_cvt_pk_bf16_f32 v215, v186, v178
    v_cvt_pk_bf16_f32 v219, v187, v179
    s_waitcnt vmcnt(7)
    v_lshlrev_b32 v140, 16, v44
    v_and_b32 v141, 0xffff0000, v44
    v_lshlrev_b32 v142, 16, v45
    v_and_b32 v143, 0xffff0000, v45
    v_lshlrev_b32 v144, 16, v46
    v_and_b32 v145, 0xffff0000, v46
    v_lshlrev_b32 v146, 16, v47
    v_and_b32 v147, 0xffff0000, v47
    v_lshlrev_b32 v164, 16, v76
    v_and_b32 v165, 0xffff0000, v76
    v_lshlrev_b32 v166, 16, v77
    v_and_b32 v167, 0xffff0000, v77
    v_lshlrev_b32 v168, 16, v78
    v_and_b32 v169, 0xffff0000, v78
    v_lshlrev_b32 v170, 16, v79
    v_and_b32 v171, 0xffff0000, v79
    v_pk_mul_f32 v[172:173], v[148:149], v[124:125]
    v_pk_fma_f32 v[172:173], v[156:157], v[116:117], v[172:173]
    v_pk_fma_f32 v[172:173], v[132:133], v[108:109], v[172:173]
    v_pk_fma_f32 v[172:173], v[140:141], v[100:101], v[172:173]
    v_pk_mul_f32 v[174:175], v[150:151], v[126:127]
    v_pk_fma_f32 v[174:175], v[158:159], v[118:119], v[174:175]
    v_pk_fma_f32 v[174:175], v[134:135], v[110:111], v[174:175]
    v_pk_fma_f32 v[174:175], v[142:143], v[102:103], v[174:175]
    v_pk_mul_f32 v[176:177], v[152:153], v[128:129]
    v_pk_fma_f32 v[176:177], v[160:161], v[120:121], v[176:177]
    v_pk_fma_f32 v[176:177], v[136:137], v[112:113], v[176:177]
    v_pk_fma_f32 v[176:177], v[144:145], v[104:105], v[176:177]
    v_pk_mul_f32 v[178:179], v[154:155], v[130:131]
    v_pk_fma_f32 v[178:179], v[162:163], v[122:123], v[178:179]
    v_pk_fma_f32 v[178:179], v[138:139], v[114:115], v[178:179]
    v_pk_fma_f32 v[178:179], v[146:147], v[106:107], v[178:179]
    v_pk_mul_f32 v[172:173], v[172:173], v[164:165]
    v_pk_mul_f32 v[174:175], v[174:175], v[166:167]
    v_pk_mul_f32 v[176:177], v[176:177], v[168:169]
    v_pk_mul_f32 v[178:179], v[178:179], v[170:171]
    s_waitcnt vmcnt(5)
    v_lshlrev_b32 v148, 16, v48
    v_and_b32 v149, 0xffff0000, v48
    v_lshlrev_b32 v150, 16, v49
    v_and_b32 v151, 0xffff0000, v49
    v_lshlrev_b32 v152, 16, v50
    v_and_b32 v153, 0xffff0000, v50
    v_lshlrev_b32 v154, 16, v51
    v_and_b32 v155, 0xffff0000, v51
    v_lshlrev_b32 v164, 16, v80
    v_and_b32 v165, 0xffff0000, v80
    v_lshlrev_b32 v166, 16, v81
    v_and_b32 v167, 0xffff0000, v81
    v_lshlrev_b32 v168, 16, v82
    v_and_b32 v169, 0xffff0000, v82
    v_lshlrev_b32 v170, 16, v83
    v_and_b32 v171, 0xffff0000, v83
    v_pk_mul_f32 v[180:181], v[156:157], v[124:125]
    v_pk_fma_f32 v[180:181], v[132:133], v[116:117], v[180:181]
    v_pk_fma_f32 v[180:181], v[140:141], v[108:109], v[180:181]
    v_pk_fma_f32 v[180:181], v[148:149], v[100:101], v[180:181]
    v_pk_mul_f32 v[182:183], v[158:159], v[126:127]
    v_pk_fma_f32 v[182:183], v[134:135], v[118:119], v[182:183]
    v_pk_fma_f32 v[182:183], v[142:143], v[110:111], v[182:183]
    v_pk_fma_f32 v[182:183], v[150:151], v[102:103], v[182:183]
    v_pk_mul_f32 v[184:185], v[160:161], v[128:129]
    v_pk_fma_f32 v[184:185], v[136:137], v[120:121], v[184:185]
    v_pk_fma_f32 v[184:185], v[144:145], v[112:113], v[184:185]
    v_pk_fma_f32 v[184:185], v[152:153], v[104:105], v[184:185]
    v_pk_mul_f32 v[186:187], v[162:163], v[130:131]
    v_pk_fma_f32 v[186:187], v[138:139], v[122:123], v[186:187]
    v_pk_fma_f32 v[186:187], v[146:147], v[114:115], v[186:187]
    v_pk_fma_f32 v[186:187], v[154:155], v[106:107], v[186:187]
    v_pk_mul_f32 v[180:181], v[180:181], v[164:165]
    v_pk_mul_f32 v[182:183], v[182:183], v[166:167]
    v_pk_mul_f32 v[184:185], v[184:185], v[168:169]
    v_pk_mul_f32 v[186:187], v[186:187], v[170:171]
    v_cvt_pk_bf16_f32 v190, v180, v172
    v_cvt_pk_bf16_f32 v194, v181, v173
    v_cvt_pk_bf16_f32 v198, v182, v174
    v_cvt_pk_bf16_f32 v202, v183, v175
    v_cvt_pk_bf16_f32 v206, v184, v176
    v_cvt_pk_bf16_f32 v210, v185, v177
    v_cvt_pk_bf16_f32 v214, v186, v178
    v_cvt_pk_bf16_f32 v218, v187, v179
    s_waitcnt vmcnt(3)
    v_lshlrev_b32 v156, 16, v52
    v_and_b32 v157, 0xffff0000, v52
    v_lshlrev_b32 v158, 16, v53
    v_and_b32 v159, 0xffff0000, v53
    v_lshlrev_b32 v160, 16, v54
    v_and_b32 v161, 0xffff0000, v54
    v_lshlrev_b32 v162, 16, v55
    v_and_b32 v163, 0xffff0000, v55
    v_lshlrev_b32 v164, 16, v84
    v_and_b32 v165, 0xffff0000, v84
    v_lshlrev_b32 v166, 16, v85
    v_and_b32 v167, 0xffff0000, v85
    v_lshlrev_b32 v168, 16, v86
    v_and_b32 v169, 0xffff0000, v86
    v_lshlrev_b32 v170, 16, v87
    v_and_b32 v171, 0xffff0000, v87
    v_pk_mul_f32 v[172:173], v[132:133], v[124:125]
    v_pk_fma_f32 v[172:173], v[140:141], v[116:117], v[172:173]
    v_pk_fma_f32 v[172:173], v[148:149], v[108:109], v[172:173]
    v_pk_fma_f32 v[172:173], v[156:157], v[100:101], v[172:173]
    v_pk_mul_f32 v[174:175], v[134:135], v[126:127]
    v_pk_fma_f32 v[174:175], v[142:143], v[118:119], v[174:175]
    v_pk_fma_f32 v[174:175], v[150:151], v[110:111], v[174:175]
    v_pk_fma_f32 v[174:175], v[158:159], v[102:103], v[174:175]
    v_pk_mul_f32 v[176:177], v[136:137], v[128:129]
    v_pk_fma_f32 v[176:177], v[144:145], v[120:121], v[176:177]
    v_pk_fma_f32 v[176:177], v[152:153], v[112:113], v[176:177]
    v_pk_fma_f32 v[176:177], v[160:161], v[104:105], v[176:177]
    v_pk_mul_f32 v[178:179], v[138:139], v[130:131]
    v_pk_fma_f32 v[178:179], v[146:147], v[122:123], v[178:179]
    v_pk_fma_f32 v[178:179], v[154:155], v[114:115], v[178:179]
    v_pk_fma_f32 v[178:179], v[162:163], v[106:107], v[178:179]
    v_pk_mul_f32 v[172:173], v[172:173], v[164:165]
    v_pk_mul_f32 v[174:175], v[174:175], v[166:167]
    v_pk_mul_f32 v[176:177], v[176:177], v[168:169]
    v_pk_mul_f32 v[178:179], v[178:179], v[170:171]
    s_waitcnt vmcnt(2)
    v_lshlrev_b32 v132, 16, v56
    v_and_b32 v133, 0xffff0000, v56
    v_lshlrev_b32 v134, 16, v57
    v_and_b32 v135, 0xffff0000, v57
    v_lshlrev_b32 v136, 16, v58
    v_and_b32 v137, 0xffff0000, v58
    v_lshlrev_b32 v138, 16, v59
    v_and_b32 v139, 0xffff0000, v59
    v_lshlrev_b32 v164, 16, v88
    v_and_b32 v165, 0xffff0000, v88
    v_lshlrev_b32 v166, 16, v89
    v_and_b32 v167, 0xffff0000, v89
    v_lshlrev_b32 v168, 16, v90
    v_and_b32 v169, 0xffff0000, v90
    v_lshlrev_b32 v170, 16, v91
    v_and_b32 v171, 0xffff0000, v91
    v_pk_mul_f32 v[180:181], v[140:141], v[124:125]
    v_pk_fma_f32 v[180:181], v[148:149], v[116:117], v[180:181]
    v_pk_fma_f32 v[180:181], v[156:157], v[108:109], v[180:181]
    v_pk_fma_f32 v[180:181], v[132:133], v[100:101], v[180:181]
    v_pk_mul_f32 v[182:183], v[142:143], v[126:127]
    v_pk_fma_f32 v[182:183], v[150:151], v[118:119], v[182:183]
    v_pk_fma_f32 v[182:183], v[158:159], v[110:111], v[182:183]
    v_pk_fma_f32 v[182:183], v[134:135], v[102:103], v[182:183]
    v_pk_mul_f32 v[184:185], v[144:145], v[128:129]
    v_pk_fma_f32 v[184:185], v[152:153], v[120:121], v[184:185]
    v_pk_fma_f32 v[184:185], v[160:161], v[112:113], v[184:185]
    v_pk_fma_f32 v[184:185], v[136:137], v[104:105], v[184:185]
    v_pk_mul_f32 v[186:187], v[146:147], v[130:131]
    v_pk_fma_f32 v[186:187], v[154:155], v[122:123], v[186:187]
    v_pk_fma_f32 v[186:187], v[162:163], v[114:115], v[186:187]
    v_pk_fma_f32 v[186:187], v[138:139], v[106:107], v[186:187]
    v_pk_mul_f32 v[180:181], v[180:181], v[164:165]
    v_pk_mul_f32 v[182:183], v[182:183], v[166:167]
    v_pk_mul_f32 v[184:185], v[184:185], v[168:169]
    v_pk_mul_f32 v[186:187], v[186:187], v[170:171]
    v_cvt_pk_bf16_f32 v189, v180, v172
    v_cvt_pk_bf16_f32 v193, v181, v173
    v_cvt_pk_bf16_f32 v197, v182, v174
    v_cvt_pk_bf16_f32 v201, v183, v175
    v_cvt_pk_bf16_f32 v205, v184, v176
    v_cvt_pk_bf16_f32 v209, v185, v177
    v_cvt_pk_bf16_f32 v213, v186, v178
    v_cvt_pk_bf16_f32 v217, v187, v179
    s_waitcnt vmcnt(1)
    v_lshlrev_b32 v140, 16, v60
    v_and_b32 v141, 0xffff0000, v60
    v_lshlrev_b32 v142, 16, v61
    v_and_b32 v143, 0xffff0000, v61
    v_lshlrev_b32 v144, 16, v62
    v_and_b32 v145, 0xffff0000, v62
    v_lshlrev_b32 v146, 16, v63
    v_and_b32 v147, 0xffff0000, v63
    v_lshlrev_b32 v164, 16, v92
    v_and_b32 v165, 0xffff0000, v92
    v_lshlrev_b32 v166, 16, v93
    v_and_b32 v167, 0xffff0000, v93
    v_lshlrev_b32 v168, 16, v94
    v_and_b32 v169, 0xffff0000, v94
    v_lshlrev_b32 v170, 16, v95
    v_and_b32 v171, 0xffff0000, v95
    v_pk_mul_f32 v[172:173], v[148:149], v[124:125]
    v_pk_fma_f32 v[172:173], v[156:157], v[116:117], v[172:173]
    v_pk_fma_f32 v[172:173], v[132:133], v[108:109], v[172:173]
    v_pk_fma_f32 v[172:173], v[140:141], v[100:101], v[172:173]
    v_pk_mul_f32 v[174:175], v[150:151], v[126:127]
    v_pk_fma_f32 v[174:175], v[158:159], v[118:119], v[174:175]
    v_pk_fma_f32 v[174:175], v[134:135], v[110:111], v[174:175]
    v_pk_fma_f32 v[174:175], v[142:143], v[102:103], v[174:175]
    v_pk_mul_f32 v[176:177], v[152:153], v[128:129]
    v_pk_fma_f32 v[176:177], v[160:161], v[120:121], v[176:177]
    v_pk_fma_f32 v[176:177], v[136:137], v[112:113], v[176:177]
    v_pk_fma_f32 v[176:177], v[144:145], v[104:105], v[176:177]
    v_pk_mul_f32 v[178:179], v[154:155], v[130:131]
    v_pk_fma_f32 v[178:179], v[162:163], v[122:123], v[178:179]
    v_pk_fma_f32 v[178:179], v[138:139], v[114:115], v[178:179]
    v_pk_fma_f32 v[178:179], v[146:147], v[106:107], v[178:179]
    v_pk_mul_f32 v[172:173], v[172:173], v[164:165]
    v_pk_mul_f32 v[174:175], v[174:175], v[166:167]
    v_pk_mul_f32 v[176:177], v[176:177], v[168:169]
    v_pk_mul_f32 v[178:179], v[178:179], v[170:171]
    s_waitcnt vmcnt(0)
    v_lshlrev_b32 v148, 16, v64
    v_and_b32 v149, 0xffff0000, v64
    v_lshlrev_b32 v150, 16, v65
    v_and_b32 v151, 0xffff0000, v65
    v_lshlrev_b32 v152, 16, v66
    v_and_b32 v153, 0xffff0000, v66
    v_lshlrev_b32 v154, 16, v67
    v_and_b32 v155, 0xffff0000, v67
    v_lshlrev_b32 v164, 16, v96
    v_and_b32 v165, 0xffff0000, v96
    v_lshlrev_b32 v166, 16, v97
    v_and_b32 v167, 0xffff0000, v97
    v_lshlrev_b32 v168, 16, v98
    v_and_b32 v169, 0xffff0000, v98
    v_lshlrev_b32 v170, 16, v99
    v_and_b32 v171, 0xffff0000, v99
    v_pk_mul_f32 v[180:181], v[156:157], v[124:125]
    v_pk_fma_f32 v[180:181], v[132:133], v[116:117], v[180:181]
    v_pk_fma_f32 v[180:181], v[140:141], v[108:109], v[180:181]
    v_pk_fma_f32 v[180:181], v[148:149], v[100:101], v[180:181]
    v_pk_mul_f32 v[182:183], v[158:159], v[126:127]
    v_pk_fma_f32 v[182:183], v[134:135], v[118:119], v[182:183]
    v_pk_fma_f32 v[182:183], v[142:143], v[110:111], v[182:183]
    v_pk_fma_f32 v[182:183], v[150:151], v[102:103], v[182:183]
    v_pk_mul_f32 v[184:185], v[160:161], v[128:129]
    v_pk_fma_f32 v[184:185], v[136:137], v[120:121], v[184:185]
    v_pk_fma_f32 v[184:185], v[144:145], v[112:113], v[184:185]
    v_pk_fma_f32 v[184:185], v[152:153], v[104:105], v[184:185]
    v_pk_mul_f32 v[186:187], v[162:163], v[130:131]
    v_pk_fma_f32 v[186:187], v[138:139], v[122:123], v[186:187]
    v_pk_fma_f32 v[186:187], v[146:147], v[114:115], v[186:187]
    v_pk_fma_f32 v[186:187], v[154:155], v[106:107], v[186:187]
    v_pk_mul_f32 v[180:181], v[180:181], v[164:165]
    v_pk_mul_f32 v[182:183], v[182:183], v[166:167]
    v_pk_mul_f32 v[184:185], v[184:185], v[168:169]
    v_pk_mul_f32 v[186:187], v[186:187], v[170:171]
    v_cvt_pk_bf16_f32 v188, v180, v172
    v_cvt_pk_bf16_f32 v192, v181, v173
    v_cvt_pk_bf16_f32 v196, v182, v174
    v_cvt_pk_bf16_f32 v200, v183, v175
    v_cvt_pk_bf16_f32 v204, v184, v176
    v_cvt_pk_bf16_f32 v208, v185, v177
    v_cvt_pk_bf16_f32 v212, v186, v178
    v_cvt_pk_bf16_f32 v216, v187, v179
    ds_write_b128 v7, v[188:191] offset:0
    ds_write_b128 v7, v[192:195] offset:128
    ds_write_b128 v7, v[196:199] offset:256
    ds_write_b128 v7, v[200:203] offset:384
    ds_write_b128 v7, v[204:207] offset:512
    ds_write_b128 v7, v[208:211] offset:640
    ds_write_b128 v7, v[212:215] offset:768
    ds_write_b128 v7, v[216:219] offset:896
    s_lshl_b32 s60, s48, 7
    s_sub_u32 s60, 3968, s60
    s_mul_i32 s61, s49, 270336
    s_add_u32 s60, s60, s61
    s_waitcnt lgkmcnt(0)
    ds_read_b128 v[188:191], v6 offset:0
    ds_read_b128 v[192:195], v6 offset:128
    ds_read_b128 v[196:199], v6 offset:256
    ds_read_b128 v[200:203], v6 offset:384
    ds_read_b128 v[204:207], v6 offset:512
    ds_read_b128 v[208:211], v6 offset:640
    ds_read_b128 v[212:215], v6 offset:768
    ds_read_b128 v[216:219], v6 offset:896
    s_waitcnt lgkmcnt(7)
    buffer_store_dwordx4 v[188:191], v3, s[56:59], s60 offen sc1
    s_add_u32 s60, s60, 4224
    s_waitcnt lgkmcnt(6)
    buffer_store_dwordx4 v[192:195], v3, s[56:59], s60 offen sc1
    s_add_u32 s60, s60, 4224
    s_waitcnt lgkmcnt(5)
    buffer_store_dwordx4 v[196:199], v3, s[56:59], s60 offen sc1
    s_add_u32 s60, s60, 4224
    s_waitcnt lgkmcnt(4)
    buffer_store_dwordx4 v[200:203], v3, s[56:59], s60 offen sc1
    s_add_u32 s60, s60, 4224
    s_waitcnt lgkmcnt(3)
    buffer_store_dwordx4 v[204:207], v3, s[56:59], s60 offen sc1
    s_add_u32 s60, s60, 4224
    s_waitcnt lgkmcnt(2)
    buffer_store_dwordx4 v[208:211], v3, s[56:59], s60 offen sc1
    s_add_u32 s60, s60, 4224
    s_waitcnt lgkmcnt(1)
    buffer_store_dwordx4 v[212:215], v3, s[56:59], s60 offen sc1
    s_add_u32 s60, s60, 4224
    s_waitcnt lgkmcnt(0)
    buffer_store_dwordx4 v[216:219], v3, s[56:59], s60 offen sc1
    s_mul_i32 s90, s90, 1664525
    s_add_u32 s90, s90, 1013904223
    s_mul_i32 s91, s91, 22695477
    s_add_u32 s91, s91, 1
    s_lshl_b32 s85, s85, 7
    s_waitcnt vmcnt(0)
    v_mov_b32 v4, s90
    v_mov_b32 v5, s91
    v_lshlrev_b32 v6, 3, v0
    s_bfm_b64 exec, 16, 0
    buffer_store_dwordx2 v[4:5], v6, s[92:95], s85 offen sc1
    s_mov_b64 exec, -1
    s_branch L_free_b
L_free_code:
    s_setprio 3
    s_getpc_b64 s[40:41]
L_pc:
    s_sub_u32 s40, s40, L_pc-recurrent_scan__ssm_conv_h3__dense_activation_relu__prompt_kernel
    s_subb_u32 s41, s41, 0
    s_mov_b32 s42, L_end-recurrent_scan__ssm_conv_h3__dense_activation_relu__prompt_kernel
    s_mov_b32 s43, 0x20000
    v_lshlrev_b32 v1, 7, v0
    s_mov_b32 s44, 0
    buffer_load_dword v200, v1, s[40:43], s44 offen
    s_add_u32 s44, s44, 8192
    buffer_load_dword v201, v1, s[40:43], s44 offen
    s_add_u32 s44, s44, 8192
    buffer_load_dword v202, v1, s[40:43], s44 offen
    s_add_u32 s44, s44, 8192
    buffer_load_dword v203, v1, s[40:43], s44 offen
    s_add_u32 s44, s44, 8192
    s_setprio 0
    s_waitcnt lgkmcnt(0)
    s_mul_i32 s90, s90, 1664525
    s_add_u32 s90, s90, 1013904223
    s_mul_i32 s91, s91, 22695477
    s_add_u32 s91, s91, 1
    s_branch L_free_b
L_free_stats:
    s_and_b32 s10, s84, 6
    s_lshl_b32 s10, s10, 8
    s_lshr_b32 s11, s84, 3
    s_lshl_b32 s11, s11, 7
    s_add_u32 s10, s10, s11
    s_and_b32 s11, s84, 1
    s_lshl_b32 s11, s11, 6
    s_add_u32 s10, s10, s11
    s_lshl_b32 s11, s85, 3
    s_add_u32 s52, s10, s11
    s_mov_b32 s40, s16
    s_mov_b32 s41, s17
    s_mov_b32 s42, 0x280000
    s_mov_b32 s43, 0x20000
    s_add_u32 s44, s38, 0x1000000
    s_addc_u32 s45, s39, 0
    s_mov_b32 s46, 0x4000
    s_mov_b32 s47, 0x20000
    s_mul_i32 s48, s52, 1280
    v_lshrrev_b32 v1, 3, v0
    v_mul_u32_u24 v2, 1280, v1
    v_and_b32 v3, 7, v0
    v_lshl_add_u32 v2, v3, 4, v2
    buffer_load_dwordx4 v[8:11], v2, s[40:43], s48 offen offset:0
    buffer_load_dwordx4 v[12:15], v2, s[40:43], s48 offen offset:128
    buffer_load_dwordx4 v[16:19], v2, s[40:43], s48 offen offset:256
    buffer_load_dwordx4 v[20:23], v2, s[40:43], s48 offen offset:384
    buffer_load_dwordx4 v[24:27], v2, s[40:43], s48 offen offset:512
    buffer_load_dwordx4 v[28:31], v2, s[40:43], s48 offen offset:640
    buffer_load_dwordx4 v[32:35], v2, s[40:43], s48 offen offset:768
    buffer_load_dwordx4 v[36:39], v2, s[40:43], s48 offen offset:896
    buffer_load_dwordx4 v[40:43], v2, s[40:43], s48 offen offset:1024
    buffer_load_dwordx4 v[44:47], v2, s[40:43], s48 offen offset:1152
    s_waitcnt vmcnt(9)
    v_lshlrev_b32 v48, 16, v8
    v_and_b32 v49, 0xffff0000, v8
    v_lshlrev_b32 v50, 16, v9
    v_and_b32 v51, 0xffff0000, v9
    v_lshlrev_b32 v52, 16, v10
    v_and_b32 v53, 0xffff0000, v10
    v_lshlrev_b32 v54, 16, v11
    v_and_b32 v55, 0xffff0000, v11
    v_pk_add_f32 v[4:5], v[48:49], v[52:53]
    v_pk_add_f32 v[6:7], v[50:51], v[54:55]
    s_waitcnt vmcnt(8)
    v_lshlrev_b32 v56, 16, v12
    v_and_b32 v57, 0xffff0000, v12
    v_lshlrev_b32 v58, 16, v13
    v_and_b32 v59, 0xffff0000, v13
    v_lshlrev_b32 v60, 16, v14
    v_and_b32 v61, 0xffff0000, v14
    v_lshlrev_b32 v62, 16, v15
    v_and_b32 v63, 0xffff0000, v15
    v_pk_add_f32 v[4:5], v[4:5], v[56:57]
    v_pk_add_f32 v[6:7], v[6:7], v[58:59]
    v_pk_add_f32 v[4:5], v[4:5], v[60:61]
    v_pk_add_f32 v[6:7], v[6:7], v[62:63]
    s_waitcnt vmcnt(7)
    v_lshlrev_b32 v64, 16, v16
    v_and_b32 v65, 0xffff0000, v16
    v_lshlrev_b32 v66, 16, v17
    v_and_b32 v67, 0xffff0000, v17
    v_lshlrev_b32 v68, 16, v18
    v_and_b32 v69, 0xffff0000, v18
    v_lshlrev_b32 v70, 16, v19
    v_and_b32 v71, 0xffff0000, v19
    v_pk_add_f32 v[4:5], v[4:5], v[64:65]
    v_pk_add_f32 v[6:7], v[6:7], v[66:67]
    v_pk_add_f32 v[4:5], v[4:5], v[68:69]
    v_pk_add_f32 v[6:7], v[6:7], v[70:71]
    s_waitcnt vmcnt(6)
    v_lshlrev_b32 v72, 16, v20
    v_and_b32 v73, 0xffff0000, v20
    v_lshlrev_b32 v74, 16, v21
    v_and_b32 v75, 0xffff0000, v21
    v_lshlrev_b32 v76, 16, v22
    v_and_b32 v77, 0xffff0000, v22
    v_lshlrev_b32 v78, 16, v23
    v_and_b32 v79, 0xffff0000, v23
    v_pk_add_f32 v[4:5], v[4:5], v[72:73]
    v_pk_add_f32 v[6:7], v[6:7], v[74:75]
    v_pk_add_f32 v[4:5], v[4:5], v[76:77]
    v_pk_add_f32 v[6:7], v[6:7], v[78:79]
    s_waitcnt vmcnt(5)
    v_lshlrev_b32 v80, 16, v24
    v_and_b32 v81, 0xffff0000, v24
    v_lshlrev_b32 v82, 16, v25
    v_and_b32 v83, 0xffff0000, v25
    v_lshlrev_b32 v84, 16, v26
    v_and_b32 v85, 0xffff0000, v26
    v_lshlrev_b32 v86, 16, v27
    v_and_b32 v87, 0xffff0000, v27
    v_pk_add_f32 v[4:5], v[4:5], v[80:81]
    v_pk_add_f32 v[6:7], v[6:7], v[82:83]
    v_pk_add_f32 v[4:5], v[4:5], v[84:85]
    v_pk_add_f32 v[6:7], v[6:7], v[86:87]
    s_waitcnt vmcnt(4)
    v_lshlrev_b32 v88, 16, v28
    v_and_b32 v89, 0xffff0000, v28
    v_lshlrev_b32 v90, 16, v29
    v_and_b32 v91, 0xffff0000, v29
    v_lshlrev_b32 v92, 16, v30
    v_and_b32 v93, 0xffff0000, v30
    v_lshlrev_b32 v94, 16, v31
    v_and_b32 v95, 0xffff0000, v31
    v_pk_add_f32 v[4:5], v[4:5], v[88:89]
    v_pk_add_f32 v[6:7], v[6:7], v[90:91]
    v_pk_add_f32 v[4:5], v[4:5], v[92:93]
    v_pk_add_f32 v[6:7], v[6:7], v[94:95]
    s_waitcnt vmcnt(3)
    v_lshlrev_b32 v96, 16, v32
    v_and_b32 v97, 0xffff0000, v32
    v_lshlrev_b32 v98, 16, v33
    v_and_b32 v99, 0xffff0000, v33
    v_lshlrev_b32 v100, 16, v34
    v_and_b32 v101, 0xffff0000, v34
    v_lshlrev_b32 v102, 16, v35
    v_and_b32 v103, 0xffff0000, v35
    v_pk_add_f32 v[4:5], v[4:5], v[96:97]
    v_pk_add_f32 v[6:7], v[6:7], v[98:99]
    v_pk_add_f32 v[4:5], v[4:5], v[100:101]
    v_pk_add_f32 v[6:7], v[6:7], v[102:103]
    s_waitcnt vmcnt(2)
    v_lshlrev_b32 v104, 16, v36
    v_and_b32 v105, 0xffff0000, v36
    v_lshlrev_b32 v106, 16, v37
    v_and_b32 v107, 0xffff0000, v37
    v_lshlrev_b32 v108, 16, v38
    v_and_b32 v109, 0xffff0000, v38
    v_lshlrev_b32 v110, 16, v39
    v_and_b32 v111, 0xffff0000, v39
    v_pk_add_f32 v[4:5], v[4:5], v[104:105]
    v_pk_add_f32 v[6:7], v[6:7], v[106:107]
    v_pk_add_f32 v[4:5], v[4:5], v[108:109]
    v_pk_add_f32 v[6:7], v[6:7], v[110:111]
    s_waitcnt vmcnt(1)
    v_lshlrev_b32 v112, 16, v40
    v_and_b32 v113, 0xffff0000, v40
    v_lshlrev_b32 v114, 16, v41
    v_and_b32 v115, 0xffff0000, v41
    v_lshlrev_b32 v116, 16, v42
    v_and_b32 v117, 0xffff0000, v42
    v_lshlrev_b32 v118, 16, v43
    v_and_b32 v119, 0xffff0000, v43
    v_pk_add_f32 v[4:5], v[4:5], v[112:113]
    v_pk_add_f32 v[6:7], v[6:7], v[114:115]
    v_pk_add_f32 v[4:5], v[4:5], v[116:117]
    v_pk_add_f32 v[6:7], v[6:7], v[118:119]
    s_waitcnt vmcnt(0)
    v_lshlrev_b32 v120, 16, v44
    v_and_b32 v121, 0xffff0000, v44
    v_lshlrev_b32 v122, 16, v45
    v_and_b32 v123, 0xffff0000, v45
    v_lshlrev_b32 v124, 16, v46
    v_and_b32 v125, 0xffff0000, v46
    v_lshlrev_b32 v126, 16, v47
    v_and_b32 v127, 0xffff0000, v47
    v_pk_add_f32 v[4:5], v[4:5], v[120:121]
    v_pk_add_f32 v[6:7], v[6:7], v[122:123]
    v_pk_add_f32 v[4:5], v[4:5], v[124:125]
    v_pk_add_f32 v[6:7], v[6:7], v[126:127]
    v_pk_add_f32 v[4:5], v[4:5], v[6:7]
    v_add_f32 v8, v4, v5
    s_nop 1
    v_add_f32_dpp v8, v8, v8 quad_perm:[1,0,3,2] row_mask:0xf bank_mask:0xf
    s_nop 1
    v_add_f32_dpp v8, v8, v8 quad_perm:[2,3,0,1] row_mask:0xf bank_mask:0xf
    s_nop 1
    v_add_f32_dpp v8, v8, v8 row_half_mirror row_mask:0xf bank_mask:0xf
    v_mul_f32 v8, 0.0015625, v8
    v_sub_f32 v10, 0, v8
    v_sub_f32 v11, 0, v8
    v_pk_add_f32 v[48:49], v[48:49], v[10:11]
    v_pk_add_f32 v[50:51], v[50:51], v[10:11]
    v_pk_add_f32 v[52:53], v[52:53], v[10:11]
    v_pk_add_f32 v[54:55], v[54:55], v[10:11]
    v_pk_add_f32 v[56:57], v[56:57], v[10:11]
    v_pk_add_f32 v[58:59], v[58:59], v[10:11]
    v_pk_add_f32 v[60:61], v[60:61], v[10:11]
    v_pk_add_f32 v[62:63], v[62:63], v[10:11]
    v_pk_add_f32 v[64:65], v[64:65], v[10:11]
    v_pk_add_f32 v[66:67], v[66:67], v[10:11]
    v_pk_add_f32 v[68:69], v[68:69], v[10:11]
    v_pk_add_f32 v[70:71], v[70:71], v[10:11]
    v_pk_add_f32 v[72:73], v[72:73], v[10:11]
    v_pk_add_f32 v[74:75], v[74:75], v[10:11]
    v_pk_add_f32 v[76:77], v[76:77], v[10:11]
    v_pk_add_f32 v[78:79], v[78:79], v[10:11]
    v_pk_add_f32 v[80:81], v[80:81], v[10:11]
    v_pk_add_f32 v[82:83], v[82:83], v[10:11]
    v_pk_add_f32 v[84:85], v[84:85], v[10:11]
    v_pk_add_f32 v[86:87], v[86:87], v[10:11]
    v_pk_add_f32 v[88:89], v[88:89], v[10:11]
    v_pk_add_f32 v[90:91], v[90:91], v[10:11]
    v_pk_add_f32 v[92:93], v[92:93], v[10:11]
    v_pk_add_f32 v[94:95], v[94:95], v[10:11]
    v_pk_add_f32 v[96:97], v[96:97], v[10:11]
    v_pk_add_f32 v[98:99], v[98:99], v[10:11]
    v_pk_add_f32 v[100:101], v[100:101], v[10:11]
    v_pk_add_f32 v[102:103], v[102:103], v[10:11]
    v_pk_add_f32 v[104:105], v[104:105], v[10:11]
    v_pk_add_f32 v[106:107], v[106:107], v[10:11]
    v_pk_add_f32 v[108:109], v[108:109], v[10:11]
    v_pk_add_f32 v[110:111], v[110:111], v[10:11]
    v_pk_add_f32 v[112:113], v[112:113], v[10:11]
    v_pk_add_f32 v[114:115], v[114:115], v[10:11]
    v_pk_add_f32 v[116:117], v[116:117], v[10:11]
    v_pk_add_f32 v[118:119], v[118:119], v[10:11]
    v_pk_add_f32 v[120:121], v[120:121], v[10:11]
    v_pk_add_f32 v[122:123], v[122:123], v[10:11]
    v_pk_add_f32 v[124:125], v[124:125], v[10:11]
    v_pk_add_f32 v[126:127], v[126:127], v[10:11]
    v_pk_mul_f32 v[4:5], v[48:49], v[48:49]
    v_pk_mul_f32 v[6:7], v[50:51], v[50:51]
    v_pk_fma_f32 v[4:5], v[52:53], v[52:53], v[4:5]
    v_pk_fma_f32 v[6:7], v[54:55], v[54:55], v[6:7]
    v_pk_fma_f32 v[4:5], v[56:57], v[56:57], v[4:5]
    v_pk_fma_f32 v[6:7], v[58:59], v[58:59], v[6:7]
    v_pk_fma_f32 v[4:5], v[60:61], v[60:61], v[4:5]
    v_pk_fma_f32 v[6:7], v[62:63], v[62:63], v[6:7]
    v_pk_fma_f32 v[4:5], v[64:65], v[64:65], v[4:5]
    v_pk_fma_f32 v[6:7], v[66:67], v[66:67], v[6:7]
    v_pk_fma_f32 v[4:5], v[68:69], v[68:69], v[4:5]
    v_pk_fma_f32 v[6:7], v[70:71], v[70:71], v[6:7]
    v_pk_fma_f32 v[4:5], v[72:73], v[72:73], v[4:5]
    v_pk_fma_f32 v[6:7], v[74:75], v[74:75], v[6:7]
    v_pk_fma_f32 v[4:5], v[76:77], v[76:77], v[4:5]
    v_pk_fma_f32 v[6:7], v[78:79], v[78:79], v[6:7]
    v_pk_fma_f32 v[4:5], v[80:81], v[80:81], v[4:5]
    v_pk_fma_f32 v[6:7], v[82:83], v[82:83], v[6:7]
    v_pk_fma_f32 v[4:5], v[84:85], v[84:85], v[4:5]
    v_pk_fma_f32 v[6:7], v[86:87], v[86:87], v[6:7]
    v_pk_fma_f32 v[4:5], v[88:89], v[88:89], v[4:5]
    v_pk_fma_f32 v[6:7], v[90:91], v[90:91], v[6:7]
    v_pk_fma_f32 v[4:5], v[92:93], v[92:93], v[4:5]
    v_pk_fma_f32 v[6:7], v[94:95], v[94:95], v[6:7]
    v_pk_fma_f32 v[4:5], v[96:97], v[96:97], v[4:5]
    v_pk_fma_f32 v[6:7], v[98:99], v[98:99], v[6:7]
    v_pk_fma_f32 v[4:5], v[100:101], v[100:101], v[4:5]
    v_pk_fma_f32 v[6:7], v[102:103], v[102:103], v[6:7]
    v_pk_fma_f32 v[4:5], v[104:105], v[104:105], v[4:5]
    v_pk_fma_f32 v[6:7], v[106:107], v[106:107], v[6:7]
    v_pk_fma_f32 v[4:5], v[108:109], v[108:109], v[4:5]
    v_pk_fma_f32 v[6:7], v[110:111], v[110:111], v[6:7]
    v_pk_fma_f32 v[4:5], v[112:113], v[112:113], v[4:5]
    v_pk_fma_f32 v[6:7], v[114:115], v[114:115], v[6:7]
    v_pk_fma_f32 v[4:5], v[116:117], v[116:117], v[4:5]
    v_pk_fma_f32 v[6:7], v[118:119], v[118:119], v[6:7]
    v_pk_fma_f32 v[4:5], v[120:121], v[120:121], v[4:5]
    v_pk_fma_f32 v[6:7], v[122:123], v[122:123], v[6:7]
    v_pk_fma_f32 v[4:5], v[124:125], v[124:125], v[4:5]
    v_pk_fma_f32 v[6:7], v[126:127], v[126:127], v[6:7]
    v_pk_add_f32 v[4:5], v[4:5], v[6:7]
    v_add_f32 v9, v4, v5
    s_nop 1
    v_add_f32_dpp v9, v9, v9 quad_perm:[1,0,3,2] row_mask:0xf bank_mask:0xf
    s_nop 1
    v_add_f32_dpp v9, v9, v9 quad_perm:[2,3,0,1] row_mask:0xf bank_mask:0xf
    s_nop 1
    v_add_f32_dpp v9, v9, v9 row_half_mirror row_mask:0xf bank_mask:0xf
    v_mul_f32 v9, 0.0015625, v9
    v_cvt_pk_bf16_f32 v12, v8, v9
    v_lshlrev_b32 v14, 16, v12
    v_and_b32 v13, 0xffff0000, v12
    v_add_f32 v13, 0x3727c5ac, v13
    v_cvt_pk_bf16_f32 v13, v13, v13
    v_and_b32 v13, 0xffff0000, v13
    v_sqrt_f32 v13, v13
    s_nop 0
    v_cvt_pk_bf16_f32 v13, v13, v13
    v_and_b32 v13, 0xffff0000, v13
    v_rcp_f32 v15, v13
    v_lshlrev_b32 v1, 3, v1
    s_lshl_b32 s48, s52, 3
    v_cmp_eq_u32 vcc, 0, v3
    s_nop 0
    s_and_saveexec_b64 s[50:51], vcc
    buffer_store_dwordx2 v[14:15], v1, s[44:47], s48 offen sc1
    s_mov_b64 exec, s[50:51]
    s_add_u32 s85, s85, 4
    s_cmp_lt_u32 s85, 8
    s_cbranch_scc1 L_free_stats
L_free_sync:
    s_waitcnt vmcnt(0) lgkmcnt(0)
    s_barrier
    s_mul_i32 s90, s90, 1664525
    s_add_u32 s90, s90, 1013904223
    s_mul_i32 s91, s91, 22695477
    s_add_u32 s91, s91, 1
    s_branch L_free_a
L_free_b:
    s_setprio 0
    s_lshl_b32 s82, s84, 2
    s_add_u32 s82, s82, s101
    s_add_u32 s82, s82, 512
    s_lshl_b32 s72, s82, 12
    s_add_u32 s60, s24, s72
    s_addc_u32 s61, s25, 0
    s_sub_u32 s62, 2621440, s72
    s_mov_b32 s63, 0x20000
    s_add_u32 s64, s38, 0xa00000
    s_addc_u32 s65, s39, 0
    s_mov_b32 s66, 0x294000
    s_mov_b32 s67, 0x20000
    s_add_u32 s68, s38, 0xd00000
    s_addc_u32 s69, s39, 0
    s_mov_b32 s70, 0x294000
    s_mov_b32 s71, 0x20000
    s_and_b32 s73, s82, 0xfffe
    s_lshl_b32 s73, s73, 1
    s_load_dword s74, s[26:27], s73
    v_lshlrev_b32 v1, 4, v0
    v_and_b32 v2, 31, v0
    v_lshlrev_b32 v2, 7, v2
    buffer_load_dword v41, v2, s[60:63], 0 offen
    v_and_b32 v6, 15, v0
    v_lshrrev_b32 v7, 4, v0
    v_add_u32 v2, v6, v7
    v_lshlrev_b32 v2, 1, v2
    v_subrev_u32 v2, 32, v2
    buffer_load_ushort v40, v2, s[60:63], 0 offen
    s_mul_i32 s72, s82, 4224
    v_mul_u32_u24 v42, 4160, v7
    v_lshl_add_u32 v42, v6, 1, v42
    v_add_u32 v42, s81, v42
    v_lshlrev_b32 v43, 3, v0
    v_add_u32 v43, s81, v43
    v_add_u32 v3, 1, v6
    v_and_b32 v4, 1, v3
    v_mul_u32_u24 v4, 4160, v4
    v_and_b32 v3, 0x1e, v3
    v_lshl_add_u32 v3, v3, 1, v4
    v_lshl_add_u32 v3, v7, 4, v3
    v_add_u32 v168, s81, v3
    v_add_u32 v169, 1024, v168
    v_add_u32 v170, 2048, v168
    v_add_u32 v171, 3072, v168
    v_lshlrev_b32 v6, 5, v6
    s_add_u32 s75, s81, 17120
    v_sub_u32 v4, s75, v6
    v_lshlrev_b32 v5, 3, v7
    v_sub_u32 v5, v4, v5
    v_add_u32 v5, 24, v5
    v_lshl_add_u32 v4, v7, 4, v4
    v_and_b32 v2, 1, v7
    v_lshl_add_u32 v6, v2, 9, v6
    v_lshrrev_b32 v7, 1, v7
    v_lshl_add_u32 v6, v7, 4, v6
    v_mov_b32 v8, 0
    v_mov_b32 v9, 0
    v_mov_b32 v10, 0
    v_mov_b32 v11, 0
    v_mov_b32 v12, 0
    v_mov_b32 v13, 0
    v_mov_b32 v14, 0
    v_mov_b32 v15, 0
    v_mov_b32 v16, 0
    v_mov_b32 v17, 0
    v_mov_b32 v18, 0
    v_mov_b32 v19, 0
    v_mov_b32 v20, 0
    v_mov_b32 v21, 0
    v_mov_b32 v22, 0
    v_mov_b32 v23, 0
    v_mov_b32 v24, 0
    v_mov_b32 v25, 0
    v_mov_b32 v26, 0
    v_mov_b32 v27, 0
    v_mov_b32 v28, 0
    v_mov_b32 v29, 0
    v_mov_b32 v30, 0
    v_mov_b32 v31, 0
    v_mov_b32 v32, 0
    v_mov_b32 v33, 0
    v_mov_b32 v34, 0
    v_mov_b32 v35, 0
    v_mov_b32 v36, 0
    v_mov_b32 v37, 0
    v_mov_b32 v38, 0
    v_mov_b32 v39, 0
    v_mov_b32 v250, 163776
    s_add_u32 m0, s81, 32
    s_mov_b32 s75, 0
    buffer_load_dwordx4 v1, s[60:63], s75 offen offset:0 lds
    buffer_load_dwordx4 v1, s[60:63], s75 offen offset:1024 lds
    buffer_load_dwordx4 v1, s[60:63], s75 offen offset:2048 lds
    buffer_load_dwordx4 v1, s[60:63], s75 offen offset:3072 lds
    s_add_u32 m0, s81, 4192
    s_mov_b32 s75, 2
    buffer_load_dwordx4 v1, s[60:63], s75 offen offset:0 lds
    buffer_load_dwordx4 v1, s[60:63], s75 offen offset:1024 lds
    buffer_load_dwordx4 v1, s[60:63], s75 offen offset:2048 lds
    buffer_load_dwordx4 v1, s[60:63], s75 offen offset:3072 lds
    s_waitcnt vmcnt(8)
    ds_write_b16 v42, v40
    ds_write_b64 v43, v[8:9] offset:20736
    s_barrier
    s_setprio 1
    s_branch L_b_c2
L_free_a:
    s_mul_i32 s10, s101, 14
    s_cmp_eq_u32 s101, 3
    s_cselect_b32 s10, 41, s10
    s_mul_i32 s11, s8, 54
    s_add_u32 s11, s11, s10
    s_lshl_b32 s76, s11, 12
    s_mul_i32 s11, s9, 54
    s_add_u32 s11, s11, s10
    s_mul_i32 s77, s11, 5120
    s_cmp_ge_u32 s101, 2
    s_cselect_b32 s79, 1073741824, 0
    s_mul_i32 s75, s101, 7
    s_min_u32 s75, s75, 20
    s_lshl_b32 s11, s8, 5
    s_add_u32 s75, s75, s11
    s_lshl_b32 s75, s75, 7
    s_add_u32 s75, s75, 77824
    s_lshl_b32 s74, s101, 14
    s_min_u32 s10, s10, 40
    s_lshl_b32 s10, s10, 2
    s_lshr_b32 s11, s9, 1
    s_add_u32 s10, s10, s11
    s_lshl_b32 s10, s10, 7
    s_add_u32 s71, s10, 45056
    s_add_u32 s44, s38, 0x700000
    s_addc_u32 s45, s39, 0
    s_mov_b32 s46, 0x21c000
    s_mov_b32 s47, 0x20000
    v_lshlrev_b32 v1, 4, v0
    v_add_u32 v2, 4096, v1
    s_cmp_lg_u32 s3, 0
    s_cbranch_scc1 L_g2w
    s_lshl_b32 s83, s2, 7
    s_add_u32 s83, s83, 45056
    v_mov_b32 v4, s90
    v_mov_b32 v5, s91
    v_lshlrev_b32 v6, 3, v0
    s_bfm_b64 exec, 16, 0
    buffer_store_dwordx2 v[4:5], v6, s[92:95], s83 offen sc1
    s_mov_b64 exec, -1
    s_lshl_b32 s62, s84, 2
    s_add_u32 s62, s62, 512
    s_lshr_b32 s10, s9, 1
    s_add_u32 s10, s10, 352
    v_lshl_add_u32 v16, v0, 2, s10
    v_mov_b32 v17, s10
    v_cmp_gt_u32 vcc, 54, v0
    s_nop 1
    v_cndmask_b32 v16, v17, v16, vcc
    v_lshlrev_b32 v16, 7, v16
    s_lshr_b32 s10, s62, 6
    s_lshr_b32 s11, s62, 6
    v_mov_b32 v17, s11
    v_mov_b32 v18, s10
    v_cmp_gt_u32 vcc, 32, v0
    s_nop 1
    v_cndmask_b32 v17, v17, v18, vcc
    v_and_b32 v18, 31, v0
    v_mad_u32_u24 v17, v18, 10, v17
    v_lshlrev_b32 v17, 7, v17
    buffer_load_dwordx2 v[20:21], v17, s[92:95], 0 offen sc1
    s_waitcnt vmcnt(0)
    s_mov_b32 s10, 0
    s_branch L_fwa_chk
L_fwa:
    buffer_load_dwordx2 v[20:21], v17, s[92:95], 0 offen sc1
    s_waitcnt vmcnt(0)
L_fwa_chk:
    v_cmp_ne_u64 vcc, s[90:91], v[20:21]
    s_nop 0
    s_and_b64 exec, exec, vcc
    s_cbranch_scc0 L_fwa_ok
    s_sleep 4
    s_add_u32 s10, s10, 1
    s_cmp_lt_u32 s10, 0x20000
    s_cbranch_scc1 L_fwa
L_fwa_ok:
    s_mov_b64 exec, -1
    v_mov_b32 v20, 163776
    v_mov_b32 v21, 1
    ds_write_b32 v20, v21 offset:16
L_fev:
    ds_read_b32 v24, v20 offset:24
    s_waitcnt lgkmcnt(0)
    v_readfirstlane_b32 s10, v24
    s_nop 0
    s_cmp_lg_u32 s10, 0
    s_cbranch_scc1 L_fev_ok
    s_sleep 4
    s_branch L_fev
L_fev_ok:
    s_mov_b32 s10, 0
L_fwb:
    buffer_load_dwordx2 v[22:23], v16, s[92:95], 0 offen sc1
    s_waitcnt vmcnt(0)
L_fwb_chk:
    v_cmp_ne_u64 vcc, s[90:91], v[22:23]
    s_nop 0
    s_and_b64 exec, exec, vcc
    s_cbranch_scc0 L_fwb_ok
    s_sleep 4
    s_add_u32 s10, s10, 1
    s_cmp_lt_u32 s10, 0x20000
    s_cbranch_scc1 L_fwb
L_fwb_ok:
    s_mov_b64 exec, -1
    ds_write_b32 v20, v21 offset:12
    s_branch L_g2w
L_a:
    s_setprio 3
    s_mul_i32 s52, s2, 6554
    s_lshr_b32 s52, s52, 16
    s_mul_i32 s53, s52, 10
    s_sub_u32 s53, s2, s53
    s_lshl_b32 s54, s52, 2
    s_add_u32 s54, s54, s101
    s_mul_i32 s54, s54, 20480
    s_lshl_b32 s55, s53, 7
    s_add_u32 s54, s54, s55
    v_lshrrev_b32 v1, 3, v0
    v_mul_u32_u24 v2, 1280, v1
    v_and_b32 v3, 7, v0
    v_lshl_add_u32 v2, v3, 4, v2
    v_add_u32 v200, s54, v2
    v_subrev_u32 v201, 3840, v200
    v_add_u32 v202, 5376, v200
    v_add_u32 v203, 14592, v200
    v_mov_b32 v6, 1073741824
    v_cmp_gt_u32 vcc, 24, v0
    s_nop 1
    v_cndmask_b32 v203, v6, v203, vcc
    v_add_u32 v204, 9216, v200
    s_mul_i32 s56, s101, 5120
    s_add_u32 s56, s56, 131072
    v_and_b32 v7, 31, v0
    s_lshl_b32 s55, s53, 9
    v_lshl_add_u32 v205, v7, 4, s55
    s_waitcnt lgkmcnt(0)
    s_mov_b32 s40, s18
    s_mov_b32 s41, s19
    s_mov_b32 s42, 0x280000
    s_mov_b32 s43, 0x20000
    s_mov_b32 m0, s56
    s_nop 0
    buffer_load_dwordx4 v201, s[40:43], 0 offen lds
    buffer_load_dwordx4 v202, s[40:43], 0 offen offset:1024 lds
    buffer_load_dwordx4 v203, s[40:43], 0 offen offset:2048 lds
    s_mov_b32 s44, s20
    s_mov_b32 s45, s21
    s_mov_b32 s46, 0x280000
    s_mov_b32 s47, 0x20000
    s_add_u32 m0, s56, 3072
    s_nop 0
    buffer_load_dwordx4 v200, s[44:47], 0 offen lds
    buffer_load_dwordx4 v204, s[44:47], 0 offen offset:1024 lds
    s_mov_b32 s48, s22
    s_mov_b32 s49, s23
    s_mov_b32 s50, 0x1400
    s_mov_b32 s51, 0x20000
    buffer_load_dwordx4 v[212:215], v205, s[48:51], 0 offen
    v_lshrrev_b32 v9, 5, v0
    v_lshlrev_b32 v10, 10, v9
    v_lshl_add_u32 v10, v7, 2, v10
    v_add_u32 v209, s56, v10
    v_sub_u32 v11, 1, v9
    v_lshlrev_b32 v11, 4, v11
    v_lshl_add_u32 v11, v7, 6, v11
    v_add_u32 v210, s56, v11
    s_barrier
    s_setprio 0
    s_add_u32 s92, s38, 0x1010000
    s_addc_u32 s93, s39, 0
    s_mov_b32 s94, 0x47800
    s_mov_b32 s95, 0x20000
    s_load_dwordx2 s[90:91], s[92:93], 40960
    s_mul_i32 s10, s101, 14
    s_cmp_eq_u32 s101, 3
    s_cselect_b32 s10, 41, s10
    s_mul_i32 s11, s8, 54
    s_add_u32 s11, s11, s10
    s_lshl_b32 s76, s11, 12
    s_mul_i32 s11, s9, 54
    s_add_u32 s11, s11, s10
    s_mul_i32 s77, s11, 5120
    s_cmp_ge_u32 s101, 2
    s_cselect_b32 s79, 1073741824, 0
    s_mul_i32 s75, s101, 7
    s_min_u32 s75, s75, 20
    s_lshl_b32 s11, s8, 5
    s_add_u32 s75, s75, s11
    s_lshl_b32 s75, s75, 7
    s_add_u32 s75, s75, 77824
    s_lshl_b32 s74, s101, 14
    s_min_u32 s10, s10, 40
    s_lshl_b32 s10, s10, 2
    s_lshr_b32 s11, s9, 1
    s_add_u32 s10, s10, s11
    s_lshl_b32 s10, s10, 7
    s_add_u32 s71, s10, 45056
    s_mov_b32 s48, s38
    s_mov_b32 s49, s39
    s_mov_b32 s50, 0x6c0000
    s_mov_b32 s51, 0x20000
    s_add_u32 s44, s38, 0x700000
    s_addc_u32 s45, s39, 0
    s_mov_b32 s46, 0x21c000
    s_mov_b32 s47, 0x20000
    s_and_b32 s52, s3, 1
    s_lshr_b32 s53, s3, 1
    v_lshlrev_b32 v1, 4, v0
    v_add_u32 v2, 4096, v1
    v_and_b32 v18, 15, v0
    v_lshrrev_b32 v19, 4, v0
    v_lshrrev_b32 v20, 1, v18
    v_xor_b32 v20, v20, v19
    v_lshlrev_b32 v20, 4, v20
    v_lshl_add_u32 v20, v18, 7, v20
    s_lshl_b32 s58, s52, 13
    s_lshl_b32 s59, s53, 12
    s_add_u32 s58, s58, s59
    v_add_u32 v10, s58, v20
    v_xor_b32 v11, 64, v10
    v_xor_b32 v12, 0x1000, v10
    v_xor_b32 v13, 0x1040, v10
    v_lshrrev_b32 v20, 2, v18
    v_and_b32 v21, 3, v18
    v_lshl_add_u32 v22, v19, 3, v20
    v_lshlrev_b32 v22, 8, v22
    v_lshl_add_u32 v22, v21, 3, v22
    v_add_u32 v22, 16384, v22
    v_and_b32 v23, 1, v19
    v_lshl_add_u32 v23, v23, 2, v20
    s_lshl_b32 s58, s53, 2
    s_lshl_b32 s59, s52, 1
    s_add_u32 s58, s58, s59
    v_xor_b32 v23, s58, v23
    v_lshl_add_u32 v14, v23, 5, v22
    v_xor_b32 v15, 32, v14
    v_xor_b32 v16, 64, v14
    v_xor_b32 v17, 96, v14
    v_mov_b32 v20, 0x3f803f80
    v_mov_b32 v21, 0x3f803f80
    v_mov_b32 v22, 0x3f803f80
    v_mov_b32 v23, 0x3f803f80
    s_xor_b32 s58, s3, 0
    s_mul_i32 s58, s58, 3072
    s_add_u32 s58, s58, 150528
    v_add_u32 v3, s58, v1
    s_xor_b32 s58, s3, 2
    s_mul_i32 s58, s58, 3072
    s_add_u32 s58, s58, 150528
    v_add_u32 v4, s58, v1
    s_xor_b32 s58, s3, 1
    s_mul_i32 s58, s58, 3072
    s_add_u32 s58, s58, 150528
    v_add_u32 v5, s58, v1
    s_lshl_b32 s58, s7, 1
    s_add_u32 s57, s58, s53
    s_lshl_b32 s59, s6, 1
    s_add_u32 s59, s59, s52
    s_lshl_b32 s56, s59, 5
    s_add_u32 s56, s56, s57
    s_lshl_b32 s56, s56, 7
    s_add_u32 s56, s56, 77824
    s_mul_i32 s59, s59, 54
    s_lshl_b32 s58, s57, 1
    s_add_u32 s58, s58, s59
    s_lshl_b32 s58, s58, 12
    s_lshl_b32 s59, s52, 12
    s_add_u32 s60, s58, s59
    s_xor_b32 s59, s59, 0x1000
    s_add_u32 s61, s58, s59
    s_lshl_b32 s59, s53, 11
    v_add_u32 v6, s59, v1
    v_xor_b32 v7, 0x800, v6
    v_mov_b32 v18, 163776
    s_lshl_b32 s58, s3, 2
    s_add_u32 s58, s58, 163808
    v_mov_b32 v19, s58
    s_waitcnt lgkmcnt(0)
    s_mul_i32 s90, s90, 1664525
    s_add_u32 s90, s90, 1013904223
    s_mul_i32 s91, s91, 22695477
    s_add_u32 s91, s91, 1
    s_waitcnt vmcnt(0)
    ds_read_b32 v112, v209 offset:0
    ds_read_b32 v113, v209 offset:128
    ds_read_b32 v114, v209 offset:256
    ds_read_b32 v115, v209 offset:384
    ds_read_b32 v116, v209 offset:512
    ds_read_b32 v117, v209 offset:640
    ds_read_b32 v118, v209 offset:768
    ds_read_b32 v119, v209 offset:896
    ds_read_b32 v120, v209 offset:1024
    ds_read_b32 v121, v209 offset:1152
    ds_read_b32 v122, v209 offset:1280
    ds_read_b32 v124, v209 offset:3072
    ds_read_b32 v125, v209 offset:3200
    ds_read_b32 v126, v209 offset:3328
    ds_read_b32 v127, v209 offset:3456
    ds_read_b32 v128, v209 offset:3584
    ds_read_b32 v129, v209 offset:3712
    ds_read_b32 v130, v209 offset:3840
    ds_read_b32 v131, v209 offset:3968
    v_lshlrev_b32 v132, 16, v212
    v_and_b32 v134, 0xffff0000, v212
    v_lshlrev_b32 v136, 16, v213
    v_and_b32 v138, 0xffff0000, v213
    v_lshlrev_b32 v133, 16, v214
    v_and_b32 v135, 0xffff0000, v214
    v_lshlrev_b32 v137, 16, v215
    v_and_b32 v139, 0xffff0000, v215
    s_waitcnt lgkmcnt(8)
    v_lshlrev_b32 v140, 16, v112
    v_and_b32 v141, 0xffff0000, v112
    v_lshlrev_b32 v142, 16, v113
    v_and_b32 v143, 0xffff0000, v113
    v_lshlrev_b32 v144, 16, v114
    v_and_b32 v145, 0xffff0000, v114
    v_lshlrev_b32 v146, 16, v115
    v_and_b32 v147, 0xffff0000, v115
    v_lshlrev_b32 v148, 16, v116
    v_and_b32 v149, 0xffff0000, v116
    v_lshlrev_b32 v150, 16, v117
    v_and_b32 v151, 0xffff0000, v117
    v_lshlrev_b32 v152, 16, v118
    v_and_b32 v153, 0xffff0000, v118
    v_lshlrev_b32 v154, 16, v119
    v_and_b32 v155, 0xffff0000, v119
    v_lshlrev_b32 v156, 16, v120
    v_and_b32 v157, 0xffff0000, v120
    v_lshlrev_b32 v158, 16, v121
    v_and_b32 v159, 0xffff0000, v121
    v_lshlrev_b32 v160, 16, v122
    v_and_b32 v161, 0xffff0000, v122
    s_waitcnt lgkmcnt(0)
    v_lshlrev_b32 v216, 16, v124
    v_and_b32 v217, 0xffff0000, v124
    v_lshlrev_b32 v218, 16, v125
    v_and_b32 v219, 0xffff0000, v125
    v_lshlrev_b32 v220, 16, v126
    v_and_b32 v221, 0xffff0000, v126
    v_lshlrev_b32 v222, 16, v127
    v_and_b32 v223, 0xffff0000, v127
    v_lshlrev_b32 v224, 16, v128
    v_and_b32 v225, 0xffff0000, v128
    v_lshlrev_b32 v226, 16, v129
    v_and_b32 v227, 0xffff0000, v129
    v_lshlrev_b32 v228, 16, v130
    v_and_b32 v229, 0xffff0000, v130
    v_lshlrev_b32 v230, 16, v131
    v_and_b32 v231, 0xffff0000, v131
    v_pk_mul_f32 v[180:181], v[140:141], v[138:139]
    v_pk_fma_f32 v[180:181], v[142:143], v[136:137], v[180:181]
    v_pk_fma_f32 v[180:181], v[144:145], v[134:135], v[180:181]
    v_pk_fma_f32 v[180:181], v[146:147], v[132:133], v[180:181]
    v_pk_mul_f32 v[180:181], v[180:181], v[216:217]
    v_pk_mul_f32 v[182:183], v[142:143], v[138:139]
    v_pk_fma_f32 v[182:183], v[144:145], v[136:137], v[182:183]
    v_pk_fma_f32 v[182:183], v[146:147], v[134:135], v[182:183]
    v_pk_fma_f32 v[182:183], v[148:149], v[132:133], v[182:183]
    v_pk_mul_f32 v[182:183], v[182:183], v[218:219]
    v_cvt_pk_bf16_f32 v187, v182, v180
    v_cvt_pk_bf16_f32 v191, v183, v181
    v_pk_mul_f32 v[180:181], v[144:145], v[138:139]
    v_pk_fma_f32 v[180:181], v[146:147], v[136:137], v[180:181]
    v_pk_fma_f32 v[180:181], v[148:149], v[134:135], v[180:181]
    v_pk_fma_f32 v[180:181], v[150:151], v[132:133], v[180:181]
    v_pk_mul_f32 v[180:181], v[180:181], v[220:221]
    v_pk_mul_f32 v[182:183], v[146:147], v[138:139]
    v_pk_fma_f32 v[182:183], v[148:149], v[136:137], v[182:183]
    v_pk_fma_f32 v[182:183], v[150:151], v[134:135], v[182:183]
    v_pk_fma_f32 v[182:183], v[152:153], v[132:133], v[182:183]
    v_pk_mul_f32 v[182:183], v[182:183], v[222:223]
    v_cvt_pk_bf16_f32 v186, v182, v180
    v_cvt_pk_bf16_f32 v190, v183, v181
    v_pk_mul_f32 v[180:181], v[148:149], v[138:139]
    v_pk_fma_f32 v[180:181], v[150:151], v[136:137], v[180:181]
    v_pk_fma_f32 v[180:181], v[152:153], v[134:135], v[180:181]
    v_pk_fma_f32 v[180:181], v[154:155], v[132:133], v[180:181]
    v_pk_mul_f32 v[180:181], v[180:181], v[224:225]
    v_pk_mul_f32 v[182:183], v[150:151], v[138:139]
    v_pk_fma_f32 v[182:183], v[152:153], v[136:137], v[182:183]
    v_pk_fma_f32 v[182:183], v[154:155], v[134:135], v[182:183]
    v_pk_fma_f32 v[182:183], v[156:157], v[132:133], v[182:183]
    v_pk_mul_f32 v[182:183], v[182:183], v[226:227]
    v_cvt_pk_bf16_f32 v185, v182, v180
    v_cvt_pk_bf16_f32 v189, v183, v181
    v_pk_mul_f32 v[180:181], v[152:153], v[138:139]
    v_pk_fma_f32 v[180:181], v[154:155], v[136:137], v[180:181]
    v_pk_fma_f32 v[180:181], v[156:157], v[134:135], v[180:181]
    v_pk_fma_f32 v[180:181], v[158:159], v[132:133], v[180:181]
    v_pk_mul_f32 v[180:181], v[180:181], v[228:229]
    v_pk_mul_f32 v[182:183], v[154:155], v[138:139]
    v_pk_fma_f32 v[182:183], v[156:157], v[136:137], v[182:183]
    v_pk_fma_f32 v[182:183], v[158:159], v[134:135], v[182:183]
    v_pk_fma_f32 v[182:183], v[160:161], v[132:133], v[182:183]
    v_pk_mul_f32 v[182:183], v[182:183], v[230:231]
    v_cvt_pk_bf16_f32 v184, v182, v180
    v_cvt_pk_bf16_f32 v188, v183, v181
    ds_write_b128 v210, v[184:187] offset:0
    ds_write_b128 v210, v[188:191] offset:32
    s_waitcnt lgkmcnt(0)
    s_barrier
    ds_read_b128 v[128:131], v10 offset:0
    ds_read_b64_tr_b16 v[112:113], v14 offset:0
    ds_read_b64_tr_b16 v[114:115], v14 offset:1024
    ds_read_b128 v[132:135], v10 offset:2048
    ds_read_b64_tr_b16 v[116:117], v15 offset:0
    ds_read_b64_tr_b16 v[118:119], v15 offset:1024
    ds_read_b128 v[136:139], v12 offset:0
    ds_read_b64_tr_b16 v[120:121], v16 offset:0
    ds_read_b64_tr_b16 v[122:123], v16 offset:1024
    ds_read_b128 v[140:143], v12 offset:2048
    ds_read_b64_tr_b16 v[124:125], v17 offset:0
    ds_read_b64_tr_b16 v[126:127], v17 offset:1024
    s_waitcnt lgkmcnt(0)
    v_mfma_f32_16x16x32_bf16 v[24:27], v[112:115], v[128:131], 0
    ds_read_b128 v[160:163], v11 offset:0
    ds_read_b64_tr_b16 v[144:145], v14 offset:8192
    v_mfma_f32_16x16x32_bf16 v[28:31], v[112:115], v[132:135], 0
    ds_read_b64_tr_b16 v[146:147], v14 offset:9216
    ds_read_b128 v[164:167], v11 offset:2048
    v_mfma_f32_16x16x32_bf16 v[32:35], v[112:115], v[136:139], 0
    ds_read_b64_tr_b16 v[148:149], v15 offset:8192
    ds_read_b64_tr_b16 v[150:151], v15 offset:9216
    v_mfma_f32_16x16x32_bf16 v[36:39], v[112:115], v[140:143], 0
    ds_read_b128 v[168:171], v13 offset:0
    ds_read_b64_tr_b16 v[152:153], v16 offset:8192
    v_mfma_f32_16x16x32_bf16 v[40:43], v[116:119], v[128:131], 0
    ds_read_b64_tr_b16 v[154:155], v16 offset:9216
    ds_read_b128 v[172:175], v13 offset:2048
    v_mfma_f32_16x16x32_bf16 v[44:47], v[116:119], v[132:135], 0
    ds_read_b64_tr_b16 v[156:157], v17 offset:8192
    ds_read_b64_tr_b16 v[158:159], v17 offset:9216
    v_mfma_f32_16x16x32_bf16 v[48:51], v[116:119], v[136:139], 0
    v_mfma_f32_16x16x32_bf16 v[52:55], v[116:119], v[140:143], 0
    v_mfma_f32_16x16x32_bf16 v[56:59], v[120:123], v[128:131], 0
    v_mfma_f32_16x16x32_bf16 v[60:63], v[120:123], v[132:135], 0
    v_mfma_f32_16x16x32_bf16 v[64:67], v[120:123], v[136:139], 0
    v_mfma_f32_16x16x32_bf16 v[68:71], v[120:123], v[140:143], 0
    v_mfma_f32_16x16x32_bf16 v[72:75], v[124:127], v[128:131], 0
    v_mfma_f32_16x16x32_bf16 v[76:79], v[124:127], v[132:135], 0
    v_mfma_f32_16x16x32_bf16 v[80:83], v[124:127], v[136:139], 0
    v_mfma_f32_16x16x32_bf16 v[84:87], v[124:127], v[140:143], 0
    v_mfma_f32_16x16x32_bf16 v[88:91], v[20:23], v[128:131], 0
    v_mfma_f32_16x16x32_bf16 v[96:99], v[112:115], v[20:23], 0
    v_mfma_f32_16x16x32_bf16 v[92:95], v[20:23], v[132:135], 0
    v_mfma_f32_16x16x32_bf16 v[100:103], v[116:119], v[20:23], 0
    s_waitcnt lgkmcnt(0)
    s_barrier
    v_mfma_f32_16x16x32_bf16 v[24:27], v[144:147], v[160:163], v[24:27]
    ds_read_b128 v[128:131], v10 offset:32768
    ds_read_b64_tr_b16 v[112:113], v14 offset:32768
    v_mfma_f32_16x16x32_bf16 v[28:31], v[144:147], v[164:167], v[28:31]
    ds_read_b64_tr_b16 v[114:115], v14 offset:33792
    ds_read_b128 v[132:135], v10 offset:34816
    v_mfma_f32_16x16x32_bf16 v[32:35], v[144:147], v[168:171], v[32:35]
    ds_read_b64_tr_b16 v[116:117], v15 offset:32768
    ds_read_b64_tr_b16 v[118:119], v15 offset:33792
    v_mfma_f32_16x16x32_bf16 v[36:39], v[144:147], v[172:175], v[36:39]
    ds_read_b128 v[136:139], v12 offset:32768
    ds_read_b64_tr_b16 v[120:121], v16 offset:32768
    v_mfma_f32_16x16x32_bf16 v[40:43], v[148:151], v[160:163], v[40:43]
    ds_read_b64_tr_b16 v[122:123], v16 offset:33792
    ds_read_b128 v[140:143], v12 offset:34816
    v_mfma_f32_16x16x32_bf16 v[44:47], v[148:151], v[164:167], v[44:47]
    ds_read_b64_tr_b16 v[124:125], v17 offset:32768
    ds_read_b64_tr_b16 v[126:127], v17 offset:33792
    v_mfma_f32_16x16x32_bf16 v[48:51], v[148:151], v[168:171], v[48:51]
    v_mfma_f32_16x16x32_bf16 v[52:55], v[148:151], v[172:175], v[52:55]
    v_mfma_f32_16x16x32_bf16 v[56:59], v[152:155], v[160:163], v[56:59]
    v_mfma_f32_16x16x32_bf16 v[60:63], v[152:155], v[164:167], v[60:63]
    v_mfma_f32_16x16x32_bf16 v[64:67], v[152:155], v[168:171], v[64:67]
    v_mfma_f32_16x16x32_bf16 v[68:71], v[152:155], v[172:175], v[68:71]
    v_mfma_f32_16x16x32_bf16 v[72:75], v[156:159], v[160:163], v[72:75]
    v_mfma_f32_16x16x32_bf16 v[76:79], v[156:159], v[164:167], v[76:79]
    v_mfma_f32_16x16x32_bf16 v[80:83], v[156:159], v[168:171], v[80:83]
    v_mfma_f32_16x16x32_bf16 v[84:87], v[156:159], v[172:175], v[84:87]
    v_mfma_f32_16x16x32_bf16 v[88:91], v[20:23], v[160:163], v[88:91]
    v_mfma_f32_16x16x32_bf16 v[96:99], v[144:147], v[20:23], v[96:99]
    v_mfma_f32_16x16x32_bf16 v[92:95], v[20:23], v[164:167], v[92:95]
    v_mfma_f32_16x16x32_bf16 v[100:103], v[148:151], v[20:23], v[100:103]
    s_waitcnt lgkmcnt(0)
    v_mfma_f32_16x16x32_bf16 v[24:27], v[112:115], v[128:131], v[24:27]
    ds_read_b128 v[160:163], v11 offset:32768
    ds_read_b64_tr_b16 v[144:145], v14 offset:40960
    v_mfma_f32_16x16x32_bf16 v[28:31], v[112:115], v[132:135], v[28:31]
    ds_read_b64_tr_b16 v[146:147], v14 offset:41984
    ds_read_b128 v[164:167], v11 offset:34816
    v_mfma_f32_16x16x32_bf16 v[32:35], v[112:115], v[136:139], v[32:35]
    ds_read_b64_tr_b16 v[148:149], v15 offset:40960
    ds_read_b64_tr_b16 v[150:151], v15 offset:41984
    v_mfma_f32_16x16x32_bf16 v[36:39], v[112:115], v[140:143], v[36:39]
    ds_read_b128 v[168:171], v13 offset:32768
    ds_read_b64_tr_b16 v[152:153], v16 offset:40960
    v_mfma_f32_16x16x32_bf16 v[40:43], v[116:119], v[128:131], v[40:43]
    ds_read_b64_tr_b16 v[154:155], v16 offset:41984
    ds_read_b128 v[172:175], v13 offset:34816
    v_mfma_f32_16x16x32_bf16 v[44:47], v[116:119], v[132:135], v[44:47]
    ds_read_b64_tr_b16 v[156:157], v17 offset:40960
    ds_read_b64_tr_b16 v[158:159], v17 offset:41984
    v_mfma_f32_16x16x32_bf16 v[48:51], v[116:119], v[136:139], v[48:51]
    v_xor_b32 v10, 0x10000, v10
    v_mfma_f32_16x16x32_bf16 v[52:55], v[116:119], v[140:143], v[52:55]
    v_xor_b32 v11, 0x10000, v11
    v_mfma_f32_16x16x32_bf16 v[56:59], v[120:123], v[128:131], v[56:59]
    v_xor_b32 v12, 0x10000, v12
    v_mfma_f32_16x16x32_bf16 v[60:63], v[120:123], v[132:135], v[60:63]
    v_xor_b32 v13, 0x10000, v13
    v_mfma_f32_16x16x32_bf16 v[64:67], v[120:123], v[136:139], v[64:67]
    v_xor_b32 v14, 0x10000, v14
    v_mfma_f32_16x16x32_bf16 v[68:71], v[120:123], v[140:143], v[68:71]
    v_xor_b32 v15, 0x10000, v15
    v_mfma_f32_16x16x32_bf16 v[72:75], v[124:127], v[128:131], v[72:75]
    v_xor_b32 v16, 0x10000, v16
    v_mfma_f32_16x16x32_bf16 v[76:79], v[124:127], v[132:135], v[76:79]
    v_xor_b32 v17, 0x10000, v17
    v_mfma_f32_16x16x32_bf16 v[80:83], v[124:127], v[136:139], v[80:83]
    v_mfma_f32_16x16x32_bf16 v[84:87], v[124:127], v[140:143], v[84:87]
    v_mfma_f32_16x16x32_bf16 v[88:91], v[20:23], v[128:131], v[88:91]
    v_mfma_f32_16x16x32_bf16 v[96:99], v[112:115], v[20:23], v[96:99]
    v_mfma_f32_16x16x32_bf16 v[92:95], v[20:23], v[132:135], v[92:95]
    v_mfma_f32_16x16x32_bf16 v[100:103], v[116:119], v[20:23], v[100:103]
    s_waitcnt lgkmcnt(0)
    s_barrier
    v_mfma_f32_16x16x32_bf16 v[24:27], v[144:147], v[160:163], v[24:27]
    ds_read_b128 v[128:131], v10 offset:0
    ds_read_b64_tr_b16 v[112:113], v14 offset:0
    v_mfma_f32_16x16x32_bf16 v[28:31], v[144:147], v[164:167], v[28:31]
    ds_read_b64_tr_b16 v[114:115], v14 offset:1024
    ds_read_b128 v[132:135], v10 offset:2048
    v_mfma_f32_16x16x32_bf16 v[32:35], v[144:147], v[168:171], v[32:35]
    ds_read_b64_tr_b16 v[116:117], v15 offset:0
    ds_read_b64_tr_b16 v[118:119], v15 offset:1024
    v_mfma_f32_16x16x32_bf16 v[36:39], v[144:147], v[172:175], v[36:39]
    ds_read_b128 v[136:139], v12 offset:0
    ds_read_b64_tr_b16 v[120:121], v16 offset:0
    v_mfma_f32_16x16x32_bf16 v[40:43], v[148:151], v[160:163], v[40:43]
    ds_read_b64_tr_b16 v[122:123], v16 offset:1024
    ds_read_b128 v[140:143], v12 offset:2048
    v_mfma_f32_16x16x32_bf16 v[44:47], v[148:151], v[164:167], v[44:47]
    ds_read_b64_tr_b16 v[124:125], v17 offset:0
    ds_read_b64_tr_b16 v[126:127], v17 offset:1024
    v_mfma_f32_16x16x32_bf16 v[48:51], v[148:151], v[168:171], v[48:51]
    v_mfma_f32_16x16x32_bf16 v[52:55], v[148:151], v[172:175], v[52:55]
    v_mfma_f32_16x16x32_bf16 v[56:59], v[152:155], v[160:163], v[56:59]
    v_mfma_f32_16x16x32_bf16 v[60:63], v[152:155], v[164:167], v[60:63]
    v_mfma_f32_16x16x32_bf16 v[64:67], v[152:155], v[168:171], v[64:67]
    v_mfma_f32_16x16x32_bf16 v[68:71], v[152:155], v[172:175], v[68:71]
    v_mfma_f32_16x16x32_bf16 v[72:75], v[156:159], v[160:163], v[72:75]
    v_mfma_f32_16x16x32_bf16 v[76:79], v[156:159], v[164:167], v[76:79]
    v_mfma_f32_16x16x32_bf16 v[80:83], v[156:159], v[168:171], v[80:83]
    v_mfma_f32_16x16x32_bf16 v[84:87], v[156:159], v[172:175], v[84:87]
    v_mfma_f32_16x16x32_bf16 v[88:91], v[20:23], v[160:163], v[88:91]
    v_mfma_f32_16x16x32_bf16 v[96:99], v[144:147], v[20:23], v[96:99]
    v_mfma_f32_16x16x32_bf16 v[92:95], v[20:23], v[164:167], v[92:95]
    v_mfma_f32_16x16x32_bf16 v[100:103], v[148:151], v[20:23], v[100:103]
    s_waitcnt lgkmcnt(0)
    v_mfma_f32_16x16x32_bf16 v[24:27], v[112:115], v[128:131], v[24:27]
    ds_read_b128 v[160:163], v11 offset:0
    ds_read_b64_tr_b16 v[144:145], v14 offset:8192
    v_mfma_f32_16x16x32_bf16 v[28:31], v[112:115], v[132:135], v[28:31]
    ds_read_b64_tr_b16 v[146:147], v14 offset:9216
    ds_read_b128 v[164:167], v11 offset:2048
    v_mfma_f32_16x16x32_bf16 v[32:35], v[112:115], v[136:139], v[32:35]
    ds_read_b64_tr_b16 v[148:149], v15 offset:8192
    ds_read_b64_tr_b16 v[150:151], v15 offset:9216
    v_mfma_f32_16x16x32_bf16 v[36:39], v[112:115], v[140:143], v[36:39]
    ds_read_b128 v[168:171], v13 offset:0
    ds_read_b64_tr_b16 v[152:153], v16 offset:8192
    v_mfma_f32_16x16x32_bf16 v[40:43], v[116:119], v[128:131], v[40:43]
    ds_read_b64_tr_b16 v[154:155], v16 offset:9216
    ds_read_b128 v[172:175], v13 offset:2048
    v_mfma_f32_16x16x32_bf16 v[44:47], v[116:119], v[132:135], v[44:47]
    ds_read_b64_tr_b16 v[156:157], v17 offset:8192
    ds_read_b64_tr_b16 v[158:159], v17 offset:9216
    v_mfma_f32_16x16x32_bf16 v[48:51], v[116:119], v[136:139], v[48:51]
    v_mfma_f32_16x16x32_bf16 v[52:55], v[116:119], v[140:143], v[52:55]
    v_mfma_f32_16x16x32_bf16 v[56:59], v[120:123], v[128:131], v[56:59]
    v_mfma_f32_16x16x32_bf16 v[60:63], v[120:123], v[132:135], v[60:63]
    v_mfma_f32_16x16x32_bf16 v[64:67], v[120:123], v[136:139], v[64:67]
    v_mfma_f32_16x16x32_bf16 v[68:71], v[120:123], v[140:143], v[68:71]
    v_mfma_f32_16x16x32_bf16 v[72:75], v[124:127], v[128:131], v[72:75]
    v_mfma_f32_16x16x32_bf16 v[76:79], v[124:127], v[132:135], v[76:79]
    v_mfma_f32_16x16x32_bf16 v[80:83], v[124:127], v[136:139], v[80:83]
    v_mfma_f32_16x16x32_bf16 v[84:87], v[124:127], v[140:143], v[84:87]
    v_mfma_f32_16x16x32_bf16 v[88:91], v[20:23], v[128:131], v[88:91]
    v_mfma_f32_16x16x32_bf16 v[96:99], v[112:115], v[20:23], v[96:99]
    v_mfma_f32_16x16x32_bf16 v[92:95], v[20:23], v[132:135], v[92:95]
    v_mfma_f32_16x16x32_bf16 v[100:103], v[116:119], v[20:23], v[100:103]
    s_waitcnt lgkmcnt(0)
    s_barrier
    v_mfma_f32_16x16x32_bf16 v[24:27], v[144:147], v[160:163], v[24:27]
    ds_read_b128 v[128:131], v10 offset:32768
    ds_read_b64_tr_b16 v[112:113], v14 offset:32768
    v_mfma_f32_16x16x32_bf16 v[28:31], v[144:147], v[164:167], v[28:31]
    ds_read_b64_tr_b16 v[114:115], v14 offset:33792
    ds_read_b128 v[132:135], v10 offset:34816
    v_mfma_f32_16x16x32_bf16 v[32:35], v[144:147], v[168:171], v[32:35]
    ds_read_b64_tr_b16 v[116:117], v15 offset:32768
    ds_read_b64_tr_b16 v[118:119], v15 offset:33792
    v_mfma_f32_16x16x32_bf16 v[36:39], v[144:147], v[172:175], v[36:39]
    ds_read_b128 v[136:139], v12 offset:32768
    ds_read_b64_tr_b16 v[120:121], v16 offset:32768
    v_mfma_f32_16x16x32_bf16 v[40:43], v[148:151], v[160:163], v[40:43]
    ds_read_b64_tr_b16 v[122:123], v16 offset:33792
    ds_read_b128 v[140:143], v12 offset:34816
    v_mfma_f32_16x16x32_bf16 v[44:47], v[148:151], v[164:167], v[44:47]
    ds_read_b64_tr_b16 v[124:125], v17 offset:32768
    ds_read_b64_tr_b16 v[126:127], v17 offset:33792
    v_mfma_f32_16x16x32_bf16 v[48:51], v[148:151], v[168:171], v[48:51]
    v_mfma_f32_16x16x32_bf16 v[52:55], v[148:151], v[172:175], v[52:55]
    v_mfma_f32_16x16x32_bf16 v[56:59], v[152:155], v[160:163], v[56:59]
    v_mfma_f32_16x16x32_bf16 v[60:63], v[152:155], v[164:167], v[60:63]
    v_mfma_f32_16x16x32_bf16 v[64:67], v[152:155], v[168:171], v[64:67]
    v_mfma_f32_16x16x32_bf16 v[68:71], v[152:155], v[172:175], v[68:71]
    v_mfma_f32_16x16x32_bf16 v[72:75], v[156:159], v[160:163], v[72:75]
    v_mfma_f32_16x16x32_bf16 v[76:79], v[156:159], v[164:167], v[76:79]
    v_mfma_f32_16x16x32_bf16 v[80:83], v[156:159], v[168:171], v[80:83]
    v_mfma_f32_16x16x32_bf16 v[84:87], v[156:159], v[172:175], v[84:87]
    v_mfma_f32_16x16x32_bf16 v[88:91], v[20:23], v[160:163], v[88:91]
    v_mfma_f32_16x16x32_bf16 v[96:99], v[144:147], v[20:23], v[96:99]
    v_mfma_f32_16x16x32_bf16 v[92:95], v[20:23], v[164:167], v[92:95]
    v_mfma_f32_16x16x32_bf16 v[100:103], v[148:151], v[20:23], v[100:103]
    s_waitcnt lgkmcnt(0)
    v_mfma_f32_16x16x32_bf16 v[24:27], v[112:115], v[128:131], v[24:27]
    ds_read_b128 v[160:163], v11 offset:32768
    ds_read_b64_tr_b16 v[144:145], v14 offset:40960
    v_mfma_f32_16x16x32_bf16 v[28:31], v[112:115], v[132:135], v[28:31]
    ds_read_b64_tr_b16 v[146:147], v14 offset:41984
    ds_read_b128 v[164:167], v11 offset:34816
    v_mfma_f32_16x16x32_bf16 v[32:35], v[112:115], v[136:139], v[32:35]
    ds_read_b64_tr_b16 v[148:149], v15 offset:40960
    ds_read_b64_tr_b16 v[150:151], v15 offset:41984
    v_mfma_f32_16x16x32_bf16 v[36:39], v[112:115], v[140:143], v[36:39]
    ds_read_b128 v[168:171], v13 offset:32768
    ds_read_b64_tr_b16 v[152:153], v16 offset:40960
    v_mfma_f32_16x16x32_bf16 v[40:43], v[116:119], v[128:131], v[40:43]
    ds_read_b64_tr_b16 v[154:155], v16 offset:41984
    ds_read_b128 v[172:175], v13 offset:34816
    v_mfma_f32_16x16x32_bf16 v[44:47], v[116:119], v[132:135], v[44:47]
    ds_read_b64_tr_b16 v[156:157], v17 offset:40960
    ds_read_b64_tr_b16 v[158:159], v17 offset:41984
    v_mfma_f32_16x16x32_bf16 v[48:51], v[116:119], v[136:139], v[48:51]
    v_xor_b32 v10, 0x10000, v10
    v_mfma_f32_16x16x32_bf16 v[52:55], v[116:119], v[140:143], v[52:55]
    v_xor_b32 v11, 0x10000, v11
    v_mfma_f32_16x16x32_bf16 v[56:59], v[120:123], v[128:131], v[56:59]
    v_xor_b32 v12, 0x10000, v12
    v_mfma_f32_16x16x32_bf16 v[60:63], v[120:123], v[132:135], v[60:63]
    v_xor_b32 v13, 0x10000, v13
    v_mfma_f32_16x16x32_bf16 v[64:67], v[120:123], v[136:139], v[64:67]
    v_xor_b32 v14, 0x10000, v14
    v_mfma_f32_16x16x32_bf16 v[68:71], v[120:123], v[140:143], v[68:71]
    v_xor_b32 v15, 0x10000, v15
    v_mfma_f32_16x16x32_bf16 v[72:75], v[124:127], v[128:131], v[72:75]
    v_xor_b32 v16, 0x10000, v16
    v_mfma_f32_16x16x32_bf16 v[76:79], v[124:127], v[132:135], v[76:79]
    v_xor_b32 v17, 0x10000, v17
    v_mfma_f32_16x16x32_bf16 v[80:83], v[124:127], v[136:139], v[80:83]
    v_mfma_f32_16x16x32_bf16 v[84:87], v[124:127], v[140:143], v[84:87]
    v_mfma_f32_16x16x32_bf16 v[88:91], v[20:23], v[128:131], v[88:91]
    v_mfma_f32_16x16x32_bf16 v[96:99], v[112:115], v[20:23], v[96:99]
    v_mfma_f32_16x16x32_bf16 v[92:95], v[20:23], v[132:135], v[92:95]
    v_mfma_f32_16x16x32_bf16 v[100:103], v[116:119], v[20:23], v[100:103]
    s_waitcnt lgkmcnt(0)
    s_barrier
    v_mfma_f32_16x16x32_bf16 v[24:27], v[144:147], v[160:163], v[24:27]
    ds_read_b128 v[128:131], v10 offset:0
    ds_read_b64_tr_b16 v[112:113], v14 offset:0
    v_mfma_f32_16x16x32_bf16 v[28:31], v[144:147], v[164:167], v[28:31]
    ds_read_b64_tr_b16 v[114:115], v14 offset:1024
    ds_read_b128 v[132:135], v10 offset:2048
    v_mfma_f32_16x16x32_bf16 v[32:35], v[144:147], v[168:171], v[32:35]
    ds_read_b64_tr_b16 v[116:117], v15 offset:0
    ds_read_b64_tr_b16 v[118:119], v15 offset:1024
    v_mfma_f32_16x16x32_bf16 v[36:39], v[144:147], v[172:175], v[36:39]
    ds_read_b128 v[136:139], v12 offset:0
    ds_read_b64_tr_b16 v[120:121], v16 offset:0
    v_mfma_f32_16x16x32_bf16 v[40:43], v[148:151], v[160:163], v[40:43]
    ds_read_b64_tr_b16 v[122:123], v16 offset:1024
    ds_read_b128 v[140:143], v12 offset:2048
    v_mfma_f32_16x16x32_bf16 v[44:47], v[148:151], v[164:167], v[44:47]
    ds_read_b64_tr_b16 v[124:125], v17 offset:0
    ds_read_b64_tr_b16 v[126:127], v17 offset:1024
    v_mfma_f32_16x16x32_bf16 v[48:51], v[148:151], v[168:171], v[48:51]
    v_mfma_f32_16x16x32_bf16 v[52:55], v[148:151], v[172:175], v[52:55]
    v_mfma_f32_16x16x32_bf16 v[56:59], v[152:155], v[160:163], v[56:59]
    v_mfma_f32_16x16x32_bf16 v[60:63], v[152:155], v[164:167], v[60:63]
    v_mfma_f32_16x16x32_bf16 v[64:67], v[152:155], v[168:171], v[64:67]
    v_mfma_f32_16x16x32_bf16 v[68:71], v[152:155], v[172:175], v[68:71]
    v_mfma_f32_16x16x32_bf16 v[72:75], v[156:159], v[160:163], v[72:75]
    v_mfma_f32_16x16x32_bf16 v[76:79], v[156:159], v[164:167], v[76:79]
    v_mfma_f32_16x16x32_bf16 v[80:83], v[156:159], v[168:171], v[80:83]
    v_mfma_f32_16x16x32_bf16 v[84:87], v[156:159], v[172:175], v[84:87]
    v_mfma_f32_16x16x32_bf16 v[88:91], v[20:23], v[160:163], v[88:91]
    v_mfma_f32_16x16x32_bf16 v[96:99], v[144:147], v[20:23], v[96:99]
    v_mfma_f32_16x16x32_bf16 v[92:95], v[20:23], v[164:167], v[92:95]
    v_mfma_f32_16x16x32_bf16 v[100:103], v[148:151], v[20:23], v[100:103]
    s_waitcnt lgkmcnt(0)
    v_mfma_f32_16x16x32_bf16 v[24:27], v[112:115], v[128:131], v[24:27]
    ds_read_b128 v[160:163], v11 offset:0
    ds_read_b64_tr_b16 v[144:145], v14 offset:8192
    v_mfma_f32_16x16x32_bf16 v[28:31], v[112:115], v[132:135], v[28:31]
    ds_read_b64_tr_b16 v[146:147], v14 offset:9216
    ds_read_b128 v[164:167], v11 offset:2048
    v_mfma_f32_16x16x32_bf16 v[32:35], v[112:115], v[136:139], v[32:35]
    ds_read_b64_tr_b16 v[148:149], v15 offset:8192
    ds_read_b64_tr_b16 v[150:151], v15 offset:9216
    v_mfma_f32_16x16x32_bf16 v[36:39], v[112:115], v[140:143], v[36:39]
    ds_read_b128 v[168:171], v13 offset:0
    ds_read_b64_tr_b16 v[152:153], v16 offset:8192
    v_mfma_f32_16x16x32_bf16 v[40:43], v[116:119], v[128:131], v[40:43]
    ds_read_b64_tr_b16 v[154:155], v16 offset:9216
    ds_read_b128 v[172:175], v13 offset:2048
    v_mfma_f32_16x16x32_bf16 v[44:47], v[116:119], v[132:135], v[44:47]
    ds_read_b64_tr_b16 v[156:157], v17 offset:8192
    ds_read_b64_tr_b16 v[158:159], v17 offset:9216
    v_mfma_f32_16x16x32_bf16 v[48:51], v[116:119], v[136:139], v[48:51]
    v_mfma_f32_16x16x32_bf16 v[52:55], v[116:119], v[140:143], v[52:55]
    v_mfma_f32_16x16x32_bf16 v[56:59], v[120:123], v[128:131], v[56:59]
    v_mfma_f32_16x16x32_bf16 v[60:63], v[120:123], v[132:135], v[60:63]
    v_mfma_f32_16x16x32_bf16 v[64:67], v[120:123], v[136:139], v[64:67]
    v_mfma_f32_16x16x32_bf16 v[68:71], v[120:123], v[140:143], v[68:71]
    v_mfma_f32_16x16x32_bf16 v[72:75], v[124:127], v[128:131], v[72:75]
    v_mfma_f32_16x16x32_bf16 v[76:79], v[124:127], v[132:135], v[76:79]
    v_mfma_f32_16x16x32_bf16 v[80:83], v[124:127], v[136:139], v[80:83]
    v_mfma_f32_16x16x32_bf16 v[84:87], v[124:127], v[140:143], v[84:87]
    v_mfma_f32_16x16x32_bf16 v[88:91], v[20:23], v[128:131], v[88:91]
    v_mfma_f32_16x16x32_bf16 v[96:99], v[112:115], v[20:23], v[96:99]
    v_mfma_f32_16x16x32_bf16 v[92:95], v[20:23], v[132:135], v[92:95]
    v_mfma_f32_16x16x32_bf16 v[100:103], v[116:119], v[20:23], v[100:103]
    s_waitcnt lgkmcnt(0)
    s_barrier
    v_mfma_f32_16x16x32_bf16 v[24:27], v[144:147], v[160:163], v[24:27]
    ds_read_b128 v[128:131], v10 offset:32768
    ds_read_b64_tr_b16 v[112:113], v14 offset:32768
    v_mfma_f32_16x16x32_bf16 v[28:31], v[144:147], v[164:167], v[28:31]
    ds_read_b64_tr_b16 v[114:115], v14 offset:33792
    ds_read_b128 v[132:135], v10 offset:34816
    v_mfma_f32_16x16x32_bf16 v[32:35], v[144:147], v[168:171], v[32:35]
    ds_read_b64_tr_b16 v[116:117], v15 offset:32768
    ds_read_b64_tr_b16 v[118:119], v15 offset:33792
    v_mfma_f32_16x16x32_bf16 v[36:39], v[144:147], v[172:175], v[36:39]
    ds_read_b128 v[136:139], v12 offset:32768
    ds_read_b64_tr_b16 v[120:121], v16 offset:32768
    v_mfma_f32_16x16x32_bf16 v[40:43], v[148:151], v[160:163], v[40:43]
    ds_read_b64_tr_b16 v[122:123], v16 offset:33792
    ds_read_b128 v[140:143], v12 offset:34816
    v_mfma_f32_16x16x32_bf16 v[44:47], v[148:151], v[164:167], v[44:47]
    ds_read_b64_tr_b16 v[124:125], v17 offset:32768
    ds_read_b64_tr_b16 v[126:127], v17 offset:33792
    v_mfma_f32_16x16x32_bf16 v[48:51], v[148:151], v[168:171], v[48:51]
    v_mfma_f32_16x16x32_bf16 v[52:55], v[148:151], v[172:175], v[52:55]
    v_mfma_f32_16x16x32_bf16 v[56:59], v[152:155], v[160:163], v[56:59]
    v_mfma_f32_16x16x32_bf16 v[60:63], v[152:155], v[164:167], v[60:63]
    v_mfma_f32_16x16x32_bf16 v[64:67], v[152:155], v[168:171], v[64:67]
    v_mfma_f32_16x16x32_bf16 v[68:71], v[152:155], v[172:175], v[68:71]
    v_mfma_f32_16x16x32_bf16 v[72:75], v[156:159], v[160:163], v[72:75]
    v_mfma_f32_16x16x32_bf16 v[76:79], v[156:159], v[164:167], v[76:79]
    v_mfma_f32_16x16x32_bf16 v[80:83], v[156:159], v[168:171], v[80:83]
    v_mfma_f32_16x16x32_bf16 v[84:87], v[156:159], v[172:175], v[84:87]
    v_mfma_f32_16x16x32_bf16 v[88:91], v[20:23], v[160:163], v[88:91]
    v_mfma_f32_16x16x32_bf16 v[96:99], v[144:147], v[20:23], v[96:99]
    v_mfma_f32_16x16x32_bf16 v[92:95], v[20:23], v[164:167], v[92:95]
    v_mfma_f32_16x16x32_bf16 v[100:103], v[148:151], v[20:23], v[100:103]
    s_waitcnt lgkmcnt(0)
    v_mfma_f32_16x16x32_bf16 v[24:27], v[112:115], v[128:131], v[24:27]
    ds_read_b128 v[160:163], v11 offset:32768
    ds_read_b64_tr_b16 v[144:145], v14 offset:40960
    v_mfma_f32_16x16x32_bf16 v[28:31], v[112:115], v[132:135], v[28:31]
    ds_read_b64_tr_b16 v[146:147], v14 offset:41984
    ds_read_b128 v[164:167], v11 offset:34816
    v_mfma_f32_16x16x32_bf16 v[32:35], v[112:115], v[136:139], v[32:35]
    ds_read_b64_tr_b16 v[148:149], v15 offset:40960
    ds_read_b64_tr_b16 v[150:151], v15 offset:41984
    v_mfma_f32_16x16x32_bf16 v[36:39], v[112:115], v[140:143], v[36:39]
    ds_read_b128 v[168:171], v13 offset:32768
    ds_read_b64_tr_b16 v[152:153], v16 offset:40960
    v_mfma_f32_16x16x32_bf16 v[40:43], v[116:119], v[128:131], v[40:43]
    ds_read_b64_tr_b16 v[154:155], v16 offset:41984
    ds_read_b128 v[172:175], v13 offset:34816
    v_mfma_f32_16x16x32_bf16 v[44:47], v[116:119], v[132:135], v[44:47]
    ds_read_b64_tr_b16 v[156:157], v17 offset:40960
    ds_read_b64_tr_b16 v[158:159], v17 offset:41984
    v_mfma_f32_16x16x32_bf16 v[48:51], v[116:119], v[136:139], v[48:51]
    v_xor_b32 v10, 0x10000, v10
    v_mfma_f32_16x16x32_bf16 v[52:55], v[116:119], v[140:143], v[52:55]
    v_xor_b32 v11, 0x10000, v11
    v_mfma_f32_16x16x32_bf16 v[56:59], v[120:123], v[128:131], v[56:59]
    v_xor_b32 v12, 0x10000, v12
    v_mfma_f32_16x16x32_bf16 v[60:63], v[120:123], v[132:135], v[60:63]
    v_xor_b32 v13, 0x10000, v13
    v_mfma_f32_16x16x32_bf16 v[64:67], v[120:123], v[136:139], v[64:67]
    v_xor_b32 v14, 0x10000, v14
    v_mfma_f32_16x16x32_bf16 v[68:71], v[120:123], v[140:143], v[68:71]
    v_xor_b32 v15, 0x10000, v15
    v_mfma_f32_16x16x32_bf16 v[72:75], v[124:127], v[128:131], v[72:75]
    v_xor_b32 v16, 0x10000, v16
    v_mfma_f32_16x16x32_bf16 v[76:79], v[124:127], v[132:135], v[76:79]
    v_xor_b32 v17, 0x10000, v17
    v_mfma_f32_16x16x32_bf16 v[80:83], v[124:127], v[136:139], v[80:83]
    v_mfma_f32_16x16x32_bf16 v[84:87], v[124:127], v[140:143], v[84:87]
    v_mfma_f32_16x16x32_bf16 v[88:91], v[20:23], v[128:131], v[88:91]
    v_mfma_f32_16x16x32_bf16 v[96:99], v[112:115], v[20:23], v[96:99]
    v_mfma_f32_16x16x32_bf16 v[92:95], v[20:23], v[132:135], v[92:95]
    v_mfma_f32_16x16x32_bf16 v[100:103], v[116:119], v[20:23], v[100:103]
    s_waitcnt lgkmcnt(0)
    s_barrier
    v_mfma_f32_16x16x32_bf16 v[24:27], v[144:147], v[160:163], v[24:27]
    ds_read_b128 v[128:131], v10 offset:0
    ds_read_b64_tr_b16 v[112:113], v14 offset:0
    v_mfma_f32_16x16x32_bf16 v[28:31], v[144:147], v[164:167], v[28:31]
    ds_read_b64_tr_b16 v[114:115], v14 offset:1024
    ds_read_b128 v[132:135], v10 offset:2048
    v_mfma_f32_16x16x32_bf16 v[32:35], v[144:147], v[168:171], v[32:35]
    ds_read_b64_tr_b16 v[116:117], v15 offset:0
    ds_read_b64_tr_b16 v[118:119], v15 offset:1024
    v_mfma_f32_16x16x32_bf16 v[36:39], v[144:147], v[172:175], v[36:39]
    ds_read_b128 v[136:139], v12 offset:0
    ds_read_b64_tr_b16 v[120:121], v16 offset:0
    v_mfma_f32_16x16x32_bf16 v[40:43], v[148:151], v[160:163], v[40:43]
    ds_read_b64_tr_b16 v[122:123], v16 offset:1024
    ds_read_b128 v[140:143], v12 offset:2048
    v_mfma_f32_16x16x32_bf16 v[44:47], v[148:151], v[164:167], v[44:47]
    ds_read_b64_tr_b16 v[124:125], v17 offset:0
    ds_read_b64_tr_b16 v[126:127], v17 offset:1024
    v_mfma_f32_16x16x32_bf16 v[48:51], v[148:151], v[168:171], v[48:51]
    v_mfma_f32_16x16x32_bf16 v[52:55], v[148:151], v[172:175], v[52:55]
    v_mfma_f32_16x16x32_bf16 v[56:59], v[152:155], v[160:163], v[56:59]
    v_mfma_f32_16x16x32_bf16 v[60:63], v[152:155], v[164:167], v[60:63]
    v_mfma_f32_16x16x32_bf16 v[64:67], v[152:155], v[168:171], v[64:67]
    v_mfma_f32_16x16x32_bf16 v[68:71], v[152:155], v[172:175], v[68:71]
    v_mfma_f32_16x16x32_bf16 v[72:75], v[156:159], v[160:163], v[72:75]
    v_mfma_f32_16x16x32_bf16 v[76:79], v[156:159], v[164:167], v[76:79]
    v_mfma_f32_16x16x32_bf16 v[80:83], v[156:159], v[168:171], v[80:83]
    v_mfma_f32_16x16x32_bf16 v[84:87], v[156:159], v[172:175], v[84:87]
    v_mfma_f32_16x16x32_bf16 v[88:91], v[20:23], v[160:163], v[88:91]
    v_mfma_f32_16x16x32_bf16 v[96:99], v[144:147], v[20:23], v[96:99]
    v_mfma_f32_16x16x32_bf16 v[92:95], v[20:23], v[164:167], v[92:95]
    v_mfma_f32_16x16x32_bf16 v[100:103], v[148:151], v[20:23], v[100:103]
    s_waitcnt lgkmcnt(0)
    v_mfma_f32_16x16x32_bf16 v[24:27], v[112:115], v[128:131], v[24:27]
    ds_read_b128 v[160:163], v11 offset:0
    ds_read_b64_tr_b16 v[144:145], v14 offset:8192
    v_mfma_f32_16x16x32_bf16 v[28:31], v[112:115], v[132:135], v[28:31]
    ds_read_b64_tr_b16 v[146:147], v14 offset:9216
    ds_read_b128 v[164:167], v11 offset:2048
    v_mfma_f32_16x16x32_bf16 v[32:35], v[112:115], v[136:139], v[32:35]
    ds_read_b64_tr_b16 v[148:149], v15 offset:8192
    ds_read_b64_tr_b16 v[150:151], v15 offset:9216
    v_mfma_f32_16x16x32_bf16 v[36:39], v[112:115], v[140:143], v[36:39]
    ds_read_b128 v[168:171], v13 offset:0
    ds_read_b64_tr_b16 v[152:153], v16 offset:8192
    v_mfma_f32_16x16x32_bf16 v[40:43], v[116:119], v[128:131], v[40:43]
    ds_read_b64_tr_b16 v[154:155], v16 offset:9216
    ds_read_b128 v[172:175], v13 offset:2048
    v_mfma_f32_16x16x32_bf16 v[44:47], v[116:119], v[132:135], v[44:47]
    ds_read_b64_tr_b16 v[156:157], v17 offset:8192
    ds_read_b64_tr_b16 v[158:159], v17 offset:9216
    v_mfma_f32_16x16x32_bf16 v[48:51], v[116:119], v[136:139], v[48:51]
    v_mfma_f32_16x16x32_bf16 v[52:55], v[116:119], v[140:143], v[52:55]
    v_mfma_f32_16x16x32_bf16 v[56:59], v[120:123], v[128:131], v[56:59]
    v_mfma_f32_16x16x32_bf16 v[60:63], v[120:123], v[132:135], v[60:63]
    v_mfma_f32_16x16x32_bf16 v[64:67], v[120:123], v[136:139], v[64:67]
    v_mfma_f32_16x16x32_bf16 v[68:71], v[120:123], v[140:143], v[68:71]
    v_mfma_f32_16x16x32_bf16 v[72:75], v[124:127], v[128:131], v[72:75]
    v_mfma_f32_16x16x32_bf16 v[76:79], v[124:127], v[132:135], v[76:79]
    v_mfma_f32_16x16x32_bf16 v[80:83], v[124:127], v[136:139], v[80:83]
    v_mfma_f32_16x16x32_bf16 v[84:87], v[124:127], v[140:143], v[84:87]
    v_mfma_f32_16x16x32_bf16 v[88:91], v[20:23], v[128:131], v[88:91]
    v_mfma_f32_16x16x32_bf16 v[96:99], v[112:115], v[20:23], v[96:99]
    v_mfma_f32_16x16x32_bf16 v[92:95], v[20:23], v[132:135], v[92:95]
    v_mfma_f32_16x16x32_bf16 v[100:103], v[116:119], v[20:23], v[100:103]
    s_waitcnt lgkmcnt(0)
    s_barrier
    v_mfma_f32_16x16x32_bf16 v[24:27], v[144:147], v[160:163], v[24:27]
    ds_read_b128 v[128:131], v10 offset:32768
    ds_read_b64_tr_b16 v[112:113], v14 offset:32768
    v_mfma_f32_16x16x32_bf16 v[28:31], v[144:147], v[164:167], v[28:31]
    ds_read_b64_tr_b16 v[114:115], v14 offset:33792
    ds_read_b128 v[132:135], v10 offset:34816
    v_mfma_f32_16x16x32_bf16 v[32:35], v[144:147], v[168:171], v[32:35]
    ds_read_b64_tr_b16 v[116:117], v15 offset:32768
    ds_read_b64_tr_b16 v[118:119], v15 offset:33792
    v_mfma_f32_16x16x32_bf16 v[36:39], v[144:147], v[172:175], v[36:39]
    ds_read_b128 v[136:139], v12 offset:32768
    ds_read_b64_tr_b16 v[120:121], v16 offset:32768
    v_mfma_f32_16x16x32_bf16 v[40:43], v[148:151], v[160:163], v[40:43]
    ds_read_b64_tr_b16 v[122:123], v16 offset:33792
    ds_read_b128 v[140:143], v12 offset:34816
    v_mfma_f32_16x16x32_bf16 v[44:47], v[148:151], v[164:167], v[44:47]
    ds_read_b64_tr_b16 v[124:125], v17 offset:32768
    ds_read_b64_tr_b16 v[126:127], v17 offset:33792
    v_mfma_f32_16x16x32_bf16 v[48:51], v[148:151], v[168:171], v[48:51]
    v_mfma_f32_16x16x32_bf16 v[52:55], v[148:151], v[172:175], v[52:55]
    v_mfma_f32_16x16x32_bf16 v[56:59], v[152:155], v[160:163], v[56:59]
    v_mfma_f32_16x16x32_bf16 v[60:63], v[152:155], v[164:167], v[60:63]
    v_mfma_f32_16x16x32_bf16 v[64:67], v[152:155], v[168:171], v[64:67]
    v_mfma_f32_16x16x32_bf16 v[68:71], v[152:155], v[172:175], v[68:71]
    v_mfma_f32_16x16x32_bf16 v[72:75], v[156:159], v[160:163], v[72:75]
    v_mfma_f32_16x16x32_bf16 v[76:79], v[156:159], v[164:167], v[76:79]
    v_mfma_f32_16x16x32_bf16 v[80:83], v[156:159], v[168:171], v[80:83]
    v_mfma_f32_16x16x32_bf16 v[84:87], v[156:159], v[172:175], v[84:87]
    v_mfma_f32_16x16x32_bf16 v[88:91], v[20:23], v[160:163], v[88:91]
    v_mfma_f32_16x16x32_bf16 v[96:99], v[144:147], v[20:23], v[96:99]
    v_mfma_f32_16x16x32_bf16 v[92:95], v[20:23], v[164:167], v[92:95]
    v_mfma_f32_16x16x32_bf16 v[100:103], v[148:151], v[20:23], v[100:103]
    s_waitcnt lgkmcnt(0)
    v_mfma_f32_16x16x32_bf16 v[24:27], v[112:115], v[128:131], v[24:27]
    ds_read_b128 v[160:163], v11 offset:32768
    ds_read_b64_tr_b16 v[144:145], v14 offset:40960
    v_mfma_f32_16x16x32_bf16 v[28:31], v[112:115], v[132:135], v[28:31]
    ds_read_b64_tr_b16 v[146:147], v14 offset:41984
    ds_read_b128 v[164:167], v11 offset:34816
    v_mfma_f32_16x16x32_bf16 v[32:35], v[112:115], v[136:139], v[32:35]
    ds_read_b64_tr_b16 v[148:149], v15 offset:40960
    ds_read_b64_tr_b16 v[150:151], v15 offset:41984
    v_mfma_f32_16x16x32_bf16 v[36:39], v[112:115], v[140:143], v[36:39]
    ds_read_b128 v[168:171], v13 offset:32768
    ds_read_b64_tr_b16 v[152:153], v16 offset:40960
    v_mfma_f32_16x16x32_bf16 v[40:43], v[116:119], v[128:131], v[40:43]
    ds_read_b64_tr_b16 v[154:155], v16 offset:41984
    ds_read_b128 v[172:175], v13 offset:34816
    v_mfma_f32_16x16x32_bf16 v[44:47], v[116:119], v[132:135], v[44:47]
    ds_read_b64_tr_b16 v[156:157], v17 offset:40960
    ds_read_b64_tr_b16 v[158:159], v17 offset:41984
    v_mfma_f32_16x16x32_bf16 v[48:51], v[116:119], v[136:139], v[48:51]
    v_xor_b32 v10, 0x10000, v10
    v_mfma_f32_16x16x32_bf16 v[52:55], v[116:119], v[140:143], v[52:55]
    v_xor_b32 v11, 0x10000, v11
    v_mfma_f32_16x16x32_bf16 v[56:59], v[120:123], v[128:131], v[56:59]
    v_xor_b32 v12, 0x10000, v12
    v_mfma_f32_16x16x32_bf16 v[60:63], v[120:123], v[132:135], v[60:63]
    v_xor_b32 v13, 0x10000, v13
    v_mfma_f32_16x16x32_bf16 v[64:67], v[120:123], v[136:139], v[64:67]
    v_xor_b32 v14, 0x10000, v14
    v_mfma_f32_16x16x32_bf16 v[68:71], v[120:123], v[140:143], v[68:71]
    v_xor_b32 v15, 0x10000, v15
    v_mfma_f32_16x16x32_bf16 v[72:75], v[124:127], v[128:131], v[72:75]
    v_xor_b32 v16, 0x10000, v16
    v_mfma_f32_16x16x32_bf16 v[76:79], v[124:127], v[132:135], v[76:79]
    v_xor_b32 v17, 0x10000, v17
    v_mfma_f32_16x16x32_bf16 v[80:83], v[124:127], v[136:139], v[80:83]
    v_mfma_f32_16x16x32_bf16 v[84:87], v[124:127], v[140:143], v[84:87]
    v_mfma_f32_16x16x32_bf16 v[88:91], v[20:23], v[128:131], v[88:91]
    v_mfma_f32_16x16x32_bf16 v[96:99], v[112:115], v[20:23], v[96:99]
    v_mfma_f32_16x16x32_bf16 v[92:95], v[20:23], v[132:135], v[92:95]
    v_mfma_f32_16x16x32_bf16 v[100:103], v[116:119], v[20:23], v[100:103]
    s_waitcnt lgkmcnt(0)
    s_barrier
    s_setprio 2
    v_mfma_f32_16x16x32_bf16 v[24:27], v[144:147], v[160:163], v[24:27]
    ds_read_b128 v[128:131], v10 offset:0
    ds_read_b64_tr_b16 v[112:113], v14 offset:0
    v_mfma_f32_16x16x32_bf16 v[28:31], v[144:147], v[164:167], v[28:31]
    ds_read_b64_tr_b16 v[114:115], v14 offset:1024
    ds_read_b128 v[132:135], v10 offset:2048
    v_mfma_f32_16x16x32_bf16 v[32:35], v[144:147], v[168:171], v[32:35]
    ds_read_b64_tr_b16 v[116:117], v15 offset:0
    ds_read_b64_tr_b16 v[118:119], v15 offset:1024
    v_mfma_f32_16x16x32_bf16 v[36:39], v[144:147], v[172:175], v[36:39]
    ds_read_b128 v[136:139], v12 offset:0
    ds_read_b64_tr_b16 v[120:121], v16 offset:0
    v_mfma_f32_16x16x32_bf16 v[40:43], v[148:151], v[160:163], v[40:43]
    ds_read_b64_tr_b16 v[122:123], v16 offset:1024
    ds_read_b128 v[140:143], v12 offset:2048
    v_mfma_f32_16x16x32_bf16 v[44:47], v[148:151], v[164:167], v[44:47]
    ds_read_b64_tr_b16 v[124:125], v17 offset:0
    ds_read_b64_tr_b16 v[126:127], v17 offset:1024
    v_mfma_f32_16x16x32_bf16 v[48:51], v[148:151], v[168:171], v[48:51]
    v_mfma_f32_16x16x32_bf16 v[52:55], v[148:151], v[172:175], v[52:55]
    v_mfma_f32_16x16x32_bf16 v[56:59], v[152:155], v[160:163], v[56:59]
    v_mfma_f32_16x16x32_bf16 v[60:63], v[152:155], v[164:167], v[60:63]
    v_mfma_f32_16x16x32_bf16 v[64:67], v[152:155], v[168:171], v[64:67]
    v_mfma_f32_16x16x32_bf16 v[68:71], v[152:155], v[172:175], v[68:71]
    v_mfma_f32_16x16x32_bf16 v[72:75], v[156:159], v[160:163], v[72:75]
    v_mfma_f32_16x16x32_bf16 v[76:79], v[156:159], v[164:167], v[76:79]
    v_mfma_f32_16x16x32_bf16 v[80:83], v[156:159], v[168:171], v[80:83]
    v_mfma_f32_16x16x32_bf16 v[84:87], v[156:159], v[172:175], v[84:87]
    v_mfma_f32_16x16x32_bf16 v[88:91], v[20:23], v[160:163], v[88:91]
    v_mfma_f32_16x16x32_bf16 v[96:99], v[144:147], v[20:23], v[96:99]
    v_mfma_f32_16x16x32_bf16 v[92:95], v[20:23], v[164:167], v[92:95]
    v_mfma_f32_16x16x32_bf16 v[100:103], v[148:151], v[20:23], v[100:103]
    s_waitcnt lgkmcnt(0)
    v_mfma_f32_16x16x32_bf16 v[24:27], v[112:115], v[128:131], v[24:27]
    ds_read_b128 v[160:163], v11 offset:0
    ds_read_b64_tr_b16 v[144:145], v14 offset:8192
    v_mfma_f32_16x16x32_bf16 v[28:31], v[112:115], v[132:135], v[28:31]
    ds_read_b64_tr_b16 v[146:147], v14 offset:9216
    ds_read_b128 v[164:167], v11 offset:2048
    v_mfma_f32_16x16x32_bf16 v[32:35], v[112:115], v[136:139], v[32:35]
    ds_read_b64_tr_b16 v[148:149], v15 offset:8192
    ds_read_b64_tr_b16 v[150:151], v15 offset:9216
    v_mfma_f32_16x16x32_bf16 v[36:39], v[112:115], v[140:143], v[36:39]
    ds_read_b128 v[168:171], v13 offset:0
    ds_read_b64_tr_b16 v[152:153], v16 offset:8192
    v_mfma_f32_16x16x32_bf16 v[40:43], v[116:119], v[128:131], v[40:43]
    ds_read_b64_tr_b16 v[154:155], v16 offset:9216
    ds_read_b128 v[172:175], v13 offset:2048
    v_mfma_f32_16x16x32_bf16 v[44:47], v[116:119], v[132:135], v[44:47]
    ds_read_b64_tr_b16 v[156:157], v17 offset:8192
    ds_read_b64_tr_b16 v[158:159], v17 offset:9216
    v_mfma_f32_16x16x32_bf16 v[48:51], v[116:119], v[136:139], v[48:51]
    v_mfma_f32_16x16x32_bf16 v[52:55], v[116:119], v[140:143], v[52:55]
    v_mfma_f32_16x16x32_bf16 v[56:59], v[120:123], v[128:131], v[56:59]
    v_mfma_f32_16x16x32_bf16 v[60:63], v[120:123], v[132:135], v[60:63]
    v_mfma_f32_16x16x32_bf16 v[64:67], v[120:123], v[136:139], v[64:67]
    v_mfma_f32_16x16x32_bf16 v[68:71], v[120:123], v[140:143], v[68:71]
    v_mfma_f32_16x16x32_bf16 v[72:75], v[124:127], v[128:131], v[72:75]
    v_mfma_f32_16x16x32_bf16 v[76:79], v[124:127], v[132:135], v[76:79]
    v_mfma_f32_16x16x32_bf16 v[80:83], v[124:127], v[136:139], v[80:83]
    v_mfma_f32_16x16x32_bf16 v[84:87], v[124:127], v[140:143], v[84:87]
    v_mfma_f32_16x16x32_bf16 v[88:91], v[20:23], v[128:131], v[88:91]
    ds_read_b128 v[176:179], v18 offset:48
    v_mfma_f32_16x16x32_bf16 v[96:99], v[112:115], v[20:23], v[96:99]
    v_mfma_f32_16x16x32_bf16 v[92:95], v[20:23], v[132:135], v[92:95]
    v_mfma_f32_16x16x32_bf16 v[100:103], v[116:119], v[20:23], v[100:103]
    s_waitcnt lgkmcnt(0)
    v_mfma_f32_16x16x32_bf16 v[24:27], v[144:147], v[160:163], v[24:27]
    v_min3_u32 v176, v176, v177, v178
    v_mfma_f32_16x16x32_bf16 v[28:31], v[144:147], v[164:167], v[28:31]
    v_min_u32 v176, v176, v179
    v_mfma_f32_16x16x32_bf16 v[32:35], v[144:147], v[168:171], v[32:35]
    v_readfirstlane_b32 s58, v176
    s_nop 0
    s_cmp_ge_u32 s58, 1
    s_cbranch_scc1 L_a9_ok
L_a9:
    ds_read_b128 v[176:179], v18 offset:48
    s_waitcnt lgkmcnt(0)
    v_min3_u32 v176, v176, v177, v178
    v_min_u32 v176, v176, v179
    s_nop 0
    v_readfirstlane_b32 s58, v176
    s_nop 0
    s_cmp_lt_u32 s58, 1
    s_cbranch_scc1 L_a9
L_a9_ok:
    v_mfma_f32_16x16x32_bf16 v[36:39], v[144:147], v[172:175], v[36:39]
    ds_read_b128 v[128:131], v10 offset:32768
    ds_read_b64_tr_b16 v[112:113], v14 offset:32768
    v_mfma_f32_16x16x32_bf16 v[40:43], v[148:151], v[160:163], v[40:43]
    ds_read_b64_tr_b16 v[114:115], v14 offset:33792
    ds_read_b128 v[132:135], v10 offset:34816
    v_mfma_f32_16x16x32_bf16 v[44:47], v[148:151], v[164:167], v[44:47]
    ds_read_b64_tr_b16 v[116:117], v15 offset:32768
    ds_read_b64_tr_b16 v[118:119], v15 offset:33792
    v_mfma_f32_16x16x32_bf16 v[48:51], v[148:151], v[168:171], v[48:51]
    ds_read_b128 v[136:139], v12 offset:32768
    ds_read_b64_tr_b16 v[120:121], v16 offset:32768
    v_mfma_f32_16x16x32_bf16 v[52:55], v[148:151], v[172:175], v[52:55]
    ds_read_b64_tr_b16 v[122:123], v16 offset:33792
    ds_read_b128 v[140:143], v12 offset:34816
    v_mfma_f32_16x16x32_bf16 v[56:59], v[152:155], v[160:163], v[56:59]
    ds_read_b64_tr_b16 v[124:125], v17 offset:32768
    ds_read_b64_tr_b16 v[126:127], v17 offset:33792
    v_mfma_f32_16x16x32_bf16 v[60:63], v[152:155], v[164:167], v[60:63]
    v_mfma_f32_16x16x32_bf16 v[64:67], v[152:155], v[168:171], v[64:67]
    v_mfma_f32_16x16x32_bf16 v[68:71], v[152:155], v[172:175], v[68:71]
    v_mfma_f32_16x16x32_bf16 v[72:75], v[156:159], v[160:163], v[72:75]
    v_mfma_f32_16x16x32_bf16 v[76:79], v[156:159], v[164:167], v[76:79]
    v_mfma_f32_16x16x32_bf16 v[80:83], v[156:159], v[168:171], v[80:83]
    v_mfma_f32_16x16x32_bf16 v[84:87], v[156:159], v[172:175], v[84:87]
    v_mfma_f32_16x16x32_bf16 v[88:91], v[20:23], v[160:163], v[88:91]
    v_mfma_f32_16x16x32_bf16 v[96:99], v[144:147], v[20:23], v[96:99]
    v_mfma_f32_16x16x32_bf16 v[92:95], v[20:23], v[164:167], v[92:95]
    v_mfma_f32_16x16x32_bf16 v[100:103], v[148:151], v[20:23], v[100:103]
    s_waitcnt lgkmcnt(0)
    v_mfma_f32_16x16x32_bf16 v[88:91], v[20:23], v[128:131], v[88:91]
    ds_read_b128 v[160:163], v11 offset:32768
    ds_read_b64_tr_b16 v[144:145], v14 offset:40960
    v_mfma_f32_16x16x32_bf16 v[96:99], v[112:115], v[20:23], v[96:99]
    ds_read_b64_tr_b16 v[146:147], v14 offset:41984
    ds_read_b128 v[164:167], v11 offset:34816
    v_mfma_f32_16x16x32_bf16 v[92:95], v[20:23], v[132:135], v[92:95]
    ds_read_b64_tr_b16 v[148:149], v15 offset:40960
    ds_read_b64_tr_b16 v[150:151], v15 offset:41984
    v_mfma_f32_16x16x32_bf16 v[100:103], v[116:119], v[20:23], v[100:103]
    ds_read_b128 v[168:171], v13 offset:32768
    ds_read_b64_tr_b16 v[152:153], v16 offset:40960
    v_mfma_f32_16x16x32_bf16 v[24:27], v[112:115], v[128:131], v[24:27]
    ds_read_b64_tr_b16 v[154:155], v16 offset:41984
    ds_read_b128 v[172:175], v13 offset:34816
    v_mfma_f32_16x16x32_bf16 v[28:31], v[112:115], v[132:135], v[28:31]
    ds_read_b64_tr_b16 v[156:157], v17 offset:40960
    ds_read_b64_tr_b16 v[158:159], v17 offset:41984
    v_mfma_f32_16x16x32_bf16 v[32:35], v[112:115], v[136:139], v[32:35]
    v_mfma_f32_16x16x32_bf16 v[36:39], v[112:115], v[140:143], v[36:39]
    v_mfma_f32_16x16x32_bf16 v[40:43], v[116:119], v[128:131], v[40:43]
    v_mfma_f32_16x16x32_bf16 v[44:47], v[116:119], v[132:135], v[44:47]
    s_waitcnt lgkmcnt(0)
    v_mfma_f32_16x16x32_bf16 v[88:91], v[20:23], v[160:163], v[88:91]
    v_mfma_f32_16x16x32_bf16 v[96:99], v[144:147], v[20:23], v[96:99]
    v_mfma_f32_16x16x32_bf16 v[92:95], v[20:23], v[164:167], v[92:95]
    v_mfma_f32_16x16x32_bf16 v[100:103], v[148:151], v[20:23], v[100:103]
    v_mfma_f32_16x16x32_bf16 v[48:51], v[116:119], v[136:139], v[48:51]
    v_mfma_f32_16x16x32_bf16 v[52:55], v[116:119], v[140:143], v[52:55]
    v_mfma_f32_16x16x32_bf16 v[56:59], v[120:123], v[128:131], v[56:59]
    v_mfma_f32_16x16x32_bf16 v[60:63], v[120:123], v[132:135], v[60:63]
    v_mfma_f32_16x16x32_bf16 v[64:67], v[120:123], v[136:139], v[64:67]
    s_nop 1
    v_mov_b32 v89, v92
    v_mfma_f32_16x16x32_bf16 v[68:71], v[120:123], v[140:143], v[68:71]
    ds_write_b64 v3, v[88:89]
    v_mfma_f32_16x16x32_bf16 v[72:75], v[124:127], v[128:131], v[72:75]
    ds_write_b128 v3, v[96:99] offset:1024
    v_mfma_f32_16x16x32_bf16 v[76:79], v[124:127], v[132:135], v[76:79]
    ds_write_b128 v3, v[100:103] offset:2048
    v_mfma_f32_16x16x32_bf16 v[80:83], v[124:127], v[136:139], v[80:83]
    v_mov_b32 v8, 11
    v_mfma_f32_16x16x32_bf16 v[84:87], v[124:127], v[140:143], v[84:87]
    s_mov_b64 exec, 1
    ds_write_b32 v19, v8
    s_mov_b64 exec, -1
    s_cmp_ge_u32 s57, 27
    s_cselect_b32 s56, 1073741824, s56
    s_cselect_b32 s60, 1073741824, s60
    s_cselect_b32 s61, 1073741824, s61
    v_mfma_f32_16x16x32_bf16 v[24:27], v[144:147], v[160:163], v[24:27]
    v_mfma_f32_16x16x32_bf16 v[40:43], v[148:151], v[160:163], v[40:43]
    v_mfma_f32_16x16x32_bf16 v[28:31], v[144:147], v[164:167], v[28:31]
    ds_read_b128 v[176:179], v18 offset:32
    v_mfma_f32_16x16x32_bf16 v[44:47], v[148:151], v[164:167], v[44:47]
    ds_read_b64 v[90:91], v4
    v_mfma_f32_16x16x32_bf16 v[32:35], v[144:147], v[168:171], v[32:35]
    ds_read_b128 v[104:107], v5 offset:1024
    v_mfma_f32_16x16x32_bf16 v[48:51], v[148:151], v[168:171], v[48:51]
    ds_read_b128 v[108:111], v5 offset:2048
    v_mfma_f32_16x16x32_bf16 v[36:39], v[144:147], v[172:175], v[36:39]
    v_mfma_f32_16x16x32_bf16 v[52:55], v[148:151], v[172:175], v[52:55]
    s_branch L_a_chk
L_a_sync:
    ds_read_b128 v[176:179], v18 offset:32
    ds_read_b64 v[90:91], v4
    ds_read_b128 v[104:107], v5 offset:1024
    ds_read_b128 v[108:111], v5 offset:2048
L_a_chk:
    s_waitcnt lgkmcnt(0)
    v_min3_u32 v176, v176, v177, v178
    v_min_u32 v176, v176, v179
    s_nop 0
    v_readfirstlane_b32 s58, v176
    s_nop 0
    s_cmp_lt_u32 s58, 11
    s_cbranch_scc1 L_a_sync
    v_mfma_f32_16x16x32_bf16 v[56:59], v[152:155], v[160:163], v[56:59]
    v_mul_f32 v88, -0.0015625, v88
    v_mul_f32 v89, -0.0015625, v89
    v_mul_f32 v90, -0.0015625, v90
    v_mfma_f32_16x16x32_bf16 v[72:75], v[156:159], v[160:163], v[72:75]
    v_mul_f32 v91, -0.0015625, v91
    v_cvt_pk_bf16_f32 v92, v88, v89
    v_cvt_pk_bf16_f32 v93, v90, v91
    v_mfma_f32_16x16x32_bf16 v[60:63], v[152:155], v[164:167], v[60:63]
    v_lshlrev_b32 v112, 16, v92
    v_and_b32 v113, 0xffff0000, v92
    v_lshlrev_b32 v114, 16, v93
    v_mfma_f32_16x16x32_bf16 v[76:79], v[156:159], v[164:167], v[76:79]
    v_and_b32 v115, 0xffff0000, v93
    v_fmac_f32 v24, v96, v112
    v_fmac_f32 v25, v97, v112
    v_mfma_f32_16x16x32_bf16 v[64:67], v[152:155], v[168:171], v[64:67]
    v_fmac_f32 v26, v98, v112
    v_fmac_f32 v27, v99, v112
    v_cvt_pk_bf16_f32 v120, v24, v25
    v_mfma_f32_16x16x32_bf16 v[80:83], v[156:159], v[168:171], v[80:83]
    v_cvt_pk_bf16_f32 v121, v26, v27
    v_fmac_f32 v40, v100, v112
    v_fmac_f32 v41, v101, v112
    v_mfma_f32_16x16x32_bf16 v[68:71], v[152:155], v[172:175], v[68:71]
    v_fmac_f32 v42, v102, v112
    v_fmac_f32 v43, v103, v112
    v_cvt_pk_bf16_f32 v122, v40, v41
    v_mfma_f32_16x16x32_bf16 v[84:87], v[156:159], v[172:175], v[84:87]
    v_cvt_pk_bf16_f32 v123, v42, v43
    v_pk_max_i16 v120, v120, 0
    v_pk_max_i16 v121, v121, 0
    v_pk_max_i16 v122, v122, 0
    v_pk_max_i16 v123, v123, 0
    buffer_store_dwordx4 v[120:123], v6, s[48:51], s60 offen offset:0 sc1
    v_fmac_f32 v28, v96, v113
    v_fmac_f32 v29, v97, v113
    v_fmac_f32 v30, v98, v113
    v_fmac_f32 v31, v99, v113
    v_cvt_pk_bf16_f32 v124, v28, v29
    v_cvt_pk_bf16_f32 v125, v30, v31
    v_fmac_f32 v44, v100, v113
    v_fmac_f32 v45, v101, v113
    v_fmac_f32 v46, v102, v113
    v_fmac_f32 v47, v103, v113
    v_cvt_pk_bf16_f32 v126, v44, v45
    v_cvt_pk_bf16_f32 v127, v46, v47
    v_pk_max_i16 v124, v124, 0
    v_pk_max_i16 v125, v125, 0
    v_pk_max_i16 v126, v126, 0
    v_pk_max_i16 v127, v127, 0
    buffer_store_dwordx4 v[124:127], v6, s[48:51], s60 offen offset:1024 sc1
    v_fmac_f32 v32, v96, v114
    v_fmac_f32 v33, v97, v114
    v_fmac_f32 v34, v98, v114
    v_fmac_f32 v35, v99, v114
    v_cvt_pk_bf16_f32 v128, v32, v33
    v_cvt_pk_bf16_f32 v129, v34, v35
    v_fmac_f32 v48, v100, v114
    v_fmac_f32 v49, v101, v114
    v_fmac_f32 v50, v102, v114
    v_fmac_f32 v51, v103, v114
    v_cvt_pk_bf16_f32 v130, v48, v49
    v_cvt_pk_bf16_f32 v131, v50, v51
    v_pk_max_i16 v128, v128, 0
    v_pk_max_i16 v129, v129, 0
    v_pk_max_i16 v130, v130, 0
    v_pk_max_i16 v131, v131, 0
    buffer_store_dwordx4 v[128:131], v7, s[48:51], s60 offen offset:0 sc1
    v_fmac_f32 v36, v96, v115
    v_fmac_f32 v37, v97, v115
    v_fmac_f32 v38, v98, v115
    v_fmac_f32 v39, v99, v115
    v_cvt_pk_bf16_f32 v132, v36, v37
    v_cvt_pk_bf16_f32 v133, v38, v39
    v_fmac_f32 v52, v100, v115
    v_fmac_f32 v53, v101, v115
    v_fmac_f32 v54, v102, v115
    v_fmac_f32 v55, v103, v115
    v_cvt_pk_bf16_f32 v134, v52, v53
    v_cvt_pk_bf16_f32 v135, v54, v55
    v_pk_max_i16 v132, v132, 0
    v_pk_max_i16 v133, v133, 0
    v_pk_max_i16 v134, v134, 0
    v_pk_max_i16 v135, v135, 0
    buffer_store_dwordx4 v[132:135], v7, s[48:51], s60 offen offset:1024 sc1
    v_fmac_f32 v56, v104, v112
    v_fmac_f32 v57, v105, v112
    v_fmac_f32 v58, v106, v112
    v_fmac_f32 v59, v107, v112
    v_cvt_pk_bf16_f32 v120, v56, v57
    v_cvt_pk_bf16_f32 v121, v58, v59
    v_fmac_f32 v72, v108, v112
    v_fmac_f32 v73, v109, v112
    v_fmac_f32 v74, v110, v112
    v_fmac_f32 v75, v111, v112
    v_cvt_pk_bf16_f32 v122, v72, v73
    v_cvt_pk_bf16_f32 v123, v74, v75
    v_pk_max_i16 v120, v120, 0
    v_pk_max_i16 v121, v121, 0
    v_pk_max_i16 v122, v122, 0
    v_pk_max_i16 v123, v123, 0
    buffer_store_dwordx4 v[120:123], v6, s[48:51], s61 offen offset:0 sc1
    v_fmac_f32 v60, v104, v113
    v_fmac_f32 v61, v105, v113
    v_fmac_f32 v62, v106, v113
    v_fmac_f32 v63, v107, v113
    v_cvt_pk_bf16_f32 v124, v60, v61
    v_cvt_pk_bf16_f32 v125, v62, v63
    v_fmac_f32 v76, v108, v113
    v_fmac_f32 v77, v109, v113
    v_fmac_f32 v78, v110, v113
    v_fmac_f32 v79, v111, v113
    v_cvt_pk_bf16_f32 v126, v76, v77
    v_mov_b32 v8, 12
    s_mov_b64 exec, 1
    ds_write_b32 v19, v8
    s_mov_b64 exec, -1
    v_cvt_pk_bf16_f32 v127, v78, v79
    v_pk_max_i16 v124, v124, 0
    v_pk_max_i16 v125, v125, 0
    v_pk_max_i16 v126, v126, 0
    v_pk_max_i16 v127, v127, 0
    buffer_store_dwordx4 v[124:127], v6, s[48:51], s61 offen offset:1024 sc1
    v_fmac_f32 v64, v104, v114
    v_fmac_f32 v65, v105, v114
    v_fmac_f32 v66, v106, v114
    v_fmac_f32 v67, v107, v114
    v_cvt_pk_bf16_f32 v128, v64, v65
    v_cvt_pk_bf16_f32 v129, v66, v67
    v_fmac_f32 v80, v108, v114
    v_fmac_f32 v81, v109, v114
    v_fmac_f32 v82, v110, v114
    v_fmac_f32 v83, v111, v114
    v_cvt_pk_bf16_f32 v130, v80, v81
    v_cvt_pk_bf16_f32 v131, v82, v83
    v_pk_max_i16 v128, v128, 0
    v_pk_max_i16 v129, v129, 0
    v_pk_max_i16 v130, v130, 0
    v_pk_max_i16 v131, v131, 0
    buffer_store_dwordx4 v[128:131], v7, s[48:51], s61 offen offset:0 sc1
    v_fmac_f32 v68, v104, v115
    v_fmac_f32 v69, v105, v115
    v_fmac_f32 v70, v106, v115
    v_fmac_f32 v71, v107, v115
    v_cvt_pk_bf16_f32 v132, v68, v69
    v_cvt_pk_bf16_f32 v133, v70, v71
    v_fmac_f32 v84, v108, v115
    v_fmac_f32 v85, v109, v115
    v_fmac_f32 v86, v110, v115
    v_fmac_f32 v87, v111, v115
    v_cvt_pk_bf16_f32 v134, v84, v85
    v_cvt_pk_bf16_f32 v135, v86, v87
    v_pk_max_i16 v132, v132, 0
    v_pk_max_i16 v133, v133, 0
    v_pk_max_i16 v134, v134, 0
    v_pk_max_i16 v135, v135, 0
    buffer_store_dwordx4 v[132:135], v7, s[48:51], s61 offen offset:1024 sc1
    s_waitcnt vmcnt(0)
    v_mov_b32 v12, s90
    v_mov_b32 v13, s91
    v_lshlrev_b32 v14, 3, v0
    s_bfm_b64 exec, 16, 0
    buffer_store_dwordx2 v[12:13], v14, s[92:95], s56 offen sc1
    s_mov_b64 exec, -1
L_g2w:
    s_setprio 0
    v_mov_b32 v10, 163776
L_aw2:
    ds_read_b32 v11, v10 offset:12
    s_waitcnt lgkmcnt(0)
    v_readfirstlane_b32 s58, v11
    s_nop 0
    s_cmp_lg_u32 s58, 0
    s_cbranch_scc1 L_aw2_ok
    s_sleep 4
    s_branch L_aw2
L_aw2_ok:
L_g2b:
    s_add_u32 s73, s77, 0
    buffer_load_dwordx4 v[176:179], v1, s[44:47], s73 offen offset:0 sc1
    buffer_load_dwordx4 v[180:183], v1, s[44:47], s73 offen offset:1024 sc1
    buffer_load_dwordx4 v[184:187], v1, s[44:47], s73 offen offset:2048 sc1
    buffer_load_dwordx4 v[188:191], v1, s[44:47], s73 offen offset:3072 sc1
    buffer_load_dwordx4 v[192:195], v2, s[44:47], s73 offen sc1
    s_add_u32 s73, s77, 5120
    buffer_load_dwordx4 v[196:199], v1, s[44:47], s73 offen offset:0 sc1
    buffer_load_dwordx4 v[200:203], v1, s[44:47], s73 offen offset:1024 sc1
    buffer_load_dwordx4 v[204:207], v1, s[44:47], s73 offen offset:2048 sc1
    buffer_load_dwordx4 v[208:211], v1, s[44:47], s73 offen offset:3072 sc1
    buffer_load_dwordx4 v[212:215], v2, s[44:47], s73 offen sc1
    s_add_u32 s73, s77, 10240
    buffer_load_dwordx4 v[216:219], v1, s[44:47], s73 offen offset:0 sc1
    buffer_load_dwordx4 v[220:223], v1, s[44:47], s73 offen offset:1024 sc1
    buffer_load_dwordx4 v[224:227], v1, s[44:47], s73 offen offset:2048 sc1
    buffer_load_dwordx4 v[228:231], v1, s[44:47], s73 offen offset:3072 sc1
    buffer_load_dwordx4 v[232:235], v2, s[44:47], s73 offen sc1
    s_add_u32 s73, s77, 15360
    buffer_load_dwordx4 v[236:239], v1, s[44:47], s73 offen offset:0 sc1
    buffer_load_dwordx4 v[240:243], v1, s[44:47], s73 offen offset:1024 sc1
    buffer_load_dwordx4 v[244:247], v1, s[44:47], s73 offen offset:2048 sc1
    buffer_load_dwordx4 v[248:251], v1, s[44:47], s73 offen offset:3072 sc1
    buffer_load_dwordx4 v[252:255], v2, s[44:47], s73 offen sc1
    s_add_u32 s73, s77, 20480
    buffer_load_dwordx4 v[156:159], v1, s[44:47], s73 offen offset:0 sc1
    buffer_load_dwordx4 v[160:163], v1, s[44:47], s73 offen offset:1024 sc1
    buffer_load_dwordx4 v[164:167], v1, s[44:47], s73 offen offset:2048 sc1
    buffer_load_dwordx4 v[168:171], v1, s[44:47], s73 offen offset:3072 sc1
    buffer_load_dwordx4 v[172:175], v2, s[44:47], s73 offen sc1
    s_mov_b32 s40, s38
    s_mov_b32 s41, s39
    s_mov_b32 s42, 0x6c0000
    s_mov_b32 s43, 0x20000
    s_lshl_b32 s52, s101, 10
    v_add_u32 v3, s52, v1
    v_xor_b32 v4, 1024, v3
    v_xor_b32 v5, 2048, v3
    v_xor_b32 v6, 3072, v3
    v_lshlrev_b32 v9, 7, v0
    s_add_u32 s78, s77, 25600
    s_add_u32 m0, s74, 0
    s_nop 0
    buffer_load_dwordx4 v1, s[44:47], s78 offen offset:0 sc1 lds
    buffer_load_dwordx4 v1, s[44:47], s78 offen offset:1024 sc1 lds
    buffer_load_dwordx4 v1, s[44:47], s78 offen offset:2048 sc1 lds
    buffer_load_dwordx4 v1, s[44:47], s78 offen offset:3072 sc1 lds
    s_add_u32 m0, s74, 4096
    s_nop 0
    buffer_load_dwordx4 v2, s[44:47], s78 offen sc1 lds
    s_add_u32 s78, s77, 40960
    s_add_u32 m0, s74, 5120
    s_nop 0
    buffer_load_dwordx4 v1, s[44:47], s78 offen offset:0 sc1 lds
    buffer_load_dwordx4 v1, s[44:47], s78 offen offset:1024 sc1 lds
    s_bfm_b64 exec, 7, 0
    buffer_load_dwordx2 v[10:11], v9, s[92:95], s75 offen sc1
    s_mov_b64 exec, -1
    buffer_load_dwordx4 v1, s[44:47], s78 offen offset:2048 sc1 lds
    buffer_load_dwordx4 v1, s[44:47], s78 offen offset:3072 sc1 lds
    s_add_u32 m0, s74, 9216
    s_nop 0
    buffer_load_dwordx4 v2, s[44:47], s78 offen sc1 lds
    s_add_u32 s78, s77, 56320
    s_add_u32 m0, s74, 10240
    s_nop 0
    buffer_load_dwordx4 v1, s[44:47], s78 offen offset:0 sc1 lds
    buffer_load_dwordx4 v1, s[44:47], s78 offen offset:1024 sc1 lds
    buffer_load_dwordx4 v1, s[44:47], s78 offen offset:2048 sc1 lds
    buffer_load_dwordx4 v1, s[44:47], s78 offen offset:3072 sc1 lds
    s_add_u32 m0, s74, 14336
    s_nop 0
    buffer_load_dwordx4 v2, s[44:47], s78 offen sc1 lds
    v_add_u32 v7, s74, v1
    v_mov_b32 v152, 163776
    s_waitcnt vmcnt(8)
    s_mov_b32 s58, 0
    s_bfm_b64 exec, 7, 0
    s_branch L_hpoll_chk
L_hpoll:
    buffer_load_dwordx2 v[10:11], v9, s[92:95], s75 offen sc1
    s_waitcnt vmcnt(0)
L_hpoll_chk:
    v_cmp_ne_u64 vcc, s[90:91], v[10:11]
    s_nop 0
    s_and_b64 exec, exec, vcc
    s_cbranch_scc0 L_hpoll_ok
    s_sleep 2
    s_add_u32 s58, s58, 1
    s_cmp_lt_u32 s58, 0x20000
    s_cbranch_scc1 L_hpoll
L_hpoll_ok:
    s_mov_b64 exec, -1
    s_add_u32 s72, s76, 0
    buffer_load_dwordx4 v[88:91], v3, s[40:43], s72 offen sc1
    buffer_load_dwordx4 v[92:95], v4, s[40:43], s72 offen sc1
    buffer_load_dwordx4 v[96:99], v5, s[40:43], s72 offen sc1
    buffer_load_dwordx4 v[100:103], v6, s[40:43], s72 offen sc1
    s_add_u32 s72, s76, 4096
    buffer_load_dwordx4 v[104:107], v3, s[40:43], s72 offen sc1
    buffer_load_dwordx4 v[108:111], v4, s[40:43], s72 offen sc1
    buffer_load_dwordx4 v[112:115], v5, s[40:43], s72 offen sc1
    buffer_load_dwordx4 v[116:119], v6, s[40:43], s72 offen sc1
    s_add_u32 s72, s76, 8192
    buffer_load_dwordx4 v[120:123], v3, s[40:43], s72 offen sc1
    buffer_load_dwordx4 v[124:127], v4, s[40:43], s72 offen sc1
    buffer_load_dwordx4 v[128:131], v5, s[40:43], s72 offen sc1
    buffer_load_dwordx4 v[132:135], v6, s[40:43], s72 offen sc1
    s_waitcnt vmcnt(8)
    v_mfma_f32_16x16x32_bf16 v[8:11], v[176:179], v[88:91], 0
    s_add_u32 s72, s76, 12288
    buffer_load_dwordx4 v[136:139], v3, s[40:43], s72 offen sc1
    v_mfma_f32_16x16x32_bf16 v[12:15], v[176:179], v[92:95], 0
    v_mfma_f32_16x16x32_bf16 v[16:19], v[176:179], v[96:99], 0
    v_mfma_f32_16x16x32_bf16 v[20:23], v[176:179], v[100:103], 0
    v_mfma_f32_16x16x32_bf16 v[24:27], v[180:183], v[88:91], 0
    buffer_load_dwordx4 v[140:143], v4, s[40:43], s72 offen sc1
    v_mfma_f32_16x16x32_bf16 v[28:31], v[180:183], v[92:95], 0
    v_mfma_f32_16x16x32_bf16 v[32:35], v[180:183], v[96:99], 0
    v_mfma_f32_16x16x32_bf16 v[36:39], v[180:183], v[100:103], 0
    v_mfma_f32_16x16x32_bf16 v[40:43], v[184:187], v[88:91], 0
    v_mfma_f32_16x16x32_bf16 v[44:47], v[184:187], v[92:95], 0
    buffer_load_dwordx4 v[144:147], v5, s[40:43], s72 offen sc1
    v_mfma_f32_16x16x32_bf16 v[48:51], v[184:187], v[96:99], 0
    v_mfma_f32_16x16x32_bf16 v[52:55], v[184:187], v[100:103], 0
    v_mfma_f32_16x16x32_bf16 v[56:59], v[188:191], v[88:91], 0
    v_mfma_f32_16x16x32_bf16 v[60:63], v[188:191], v[92:95], 0
    buffer_load_dwordx4 v[148:151], v6, s[40:43], s72 offen sc1
    v_mfma_f32_16x16x32_bf16 v[64:67], v[188:191], v[96:99], 0
    v_mfma_f32_16x16x32_bf16 v[68:71], v[188:191], v[100:103], 0
    v_mfma_f32_16x16x32_bf16 v[72:75], v[192:195], v[88:91], 0
    v_mfma_f32_16x16x32_bf16 v[76:79], v[192:195], v[92:95], 0
    v_mfma_f32_16x16x32_bf16 v[80:83], v[192:195], v[96:99], 0
    v_mfma_f32_16x16x32_bf16 v[84:87], v[192:195], v[100:103], 0
    s_waitcnt vmcnt(8)
    v_mfma_f32_16x16x32_bf16 v[8:11], v[196:199], v[104:107], v[8:11]
    s_add_u32 s72, s76, 16384
    buffer_load_dwordx4 v[88:91], v3, s[40:43], s72 offen sc1
    v_mfma_f32_16x16x32_bf16 v[12:15], v[196:199], v[108:111], v[12:15]
    v_mfma_f32_16x16x32_bf16 v[16:19], v[196:199], v[112:115], v[16:19]
    v_mfma_f32_16x16x32_bf16 v[20:23], v[196:199], v[116:119], v[20:23]
    v_mfma_f32_16x16x32_bf16 v[24:27], v[200:203], v[104:107], v[24:27]
    buffer_load_dwordx4 v[92:95], v4, s[40:43], s72 offen sc1
    v_mfma_f32_16x16x32_bf16 v[28:31], v[200:203], v[108:111], v[28:31]
    v_mfma_f32_16x16x32_bf16 v[32:35], v[200:203], v[112:115], v[32:35]
    v_mfma_f32_16x16x32_bf16 v[36:39], v[200:203], v[116:119], v[36:39]
    v_mfma_f32_16x16x32_bf16 v[40:43], v[204:207], v[104:107], v[40:43]
    v_mfma_f32_16x16x32_bf16 v[44:47], v[204:207], v[108:111], v[44:47]
    buffer_load_dwordx4 v[96:99], v5, s[40:43], s72 offen sc1
    v_mfma_f32_16x16x32_bf16 v[48:51], v[204:207], v[112:115], v[48:51]
    v_mfma_f32_16x16x32_bf16 v[52:55], v[204:207], v[116:119], v[52:55]
    v_mfma_f32_16x16x32_bf16 v[56:59], v[208:211], v[104:107], v[56:59]
    v_mfma_f32_16x16x32_bf16 v[60:63], v[208:211], v[108:111], v[60:63]
    buffer_load_dwordx4 v[100:103], v6, s[40:43], s72 offen sc1
    v_mfma_f32_16x16x32_bf16 v[64:67], v[208:211], v[112:115], v[64:67]
    v_mfma_f32_16x16x32_bf16 v[68:71], v[208:211], v[116:119], v[68:71]
    v_mfma_f32_16x16x32_bf16 v[72:75], v[212:215], v[104:107], v[72:75]
    v_mfma_f32_16x16x32_bf16 v[76:79], v[212:215], v[108:111], v[76:79]
    v_mfma_f32_16x16x32_bf16 v[80:83], v[212:215], v[112:115], v[80:83]
    v_mfma_f32_16x16x32_bf16 v[84:87], v[212:215], v[116:119], v[84:87]
    s_waitcnt vmcnt(8)
    v_mfma_f32_16x16x32_bf16 v[8:11], v[216:219], v[120:123], v[8:11]
    s_add_u32 s72, s76, 20480
    buffer_load_dwordx4 v[104:107], v3, s[40:43], s72 offen sc1
    v_mfma_f32_16x16x32_bf16 v[12:15], v[216:219], v[124:127], v[12:15]
    v_mfma_f32_16x16x32_bf16 v[16:19], v[216:219], v[128:131], v[16:19]
    v_mfma_f32_16x16x32_bf16 v[20:23], v[216:219], v[132:135], v[20:23]
    buffer_load_dwordx4 v[108:111], v4, s[40:43], s72 offen sc1
    v_mfma_f32_16x16x32_bf16 v[24:27], v[220:223], v[120:123], v[24:27]
    v_mfma_f32_16x16x32_bf16 v[28:31], v[220:223], v[124:127], v[28:31]
    v_mfma_f32_16x16x32_bf16 v[32:35], v[220:223], v[128:131], v[32:35]
    buffer_load_dwordx4 v[112:115], v5, s[40:43], s72 offen sc1
    v_mfma_f32_16x16x32_bf16 v[36:39], v[220:223], v[132:135], v[36:39]
    v_mfma_f32_16x16x32_bf16 v[40:43], v[224:227], v[120:123], v[40:43]
    v_mfma_f32_16x16x32_bf16 v[44:47], v[224:227], v[124:127], v[44:47]
    buffer_load_dwordx4 v[116:119], v6, s[40:43], s72 offen sc1
    v_mfma_f32_16x16x32_bf16 v[48:51], v[224:227], v[128:131], v[48:51]
    v_mfma_f32_16x16x32_bf16 v[52:55], v[224:227], v[132:135], v[52:55]
    v_mfma_f32_16x16x32_bf16 v[56:59], v[228:231], v[120:123], v[56:59]
    s_add_u32 s73, s77, 30720
    buffer_load_dwordx4 v[196:199], v1, s[44:47], s73 offen offset:0 sc1
    v_mfma_f32_16x16x32_bf16 v[60:63], v[228:231], v[124:127], v[60:63]
    v_mfma_f32_16x16x32_bf16 v[64:67], v[228:231], v[128:131], v[64:67]
    v_mfma_f32_16x16x32_bf16 v[68:71], v[228:231], v[132:135], v[68:71]
    buffer_load_dwordx4 v[200:203], v1, s[44:47], s73 offen offset:1024 sc1
    v_mfma_f32_16x16x32_bf16 v[72:75], v[232:235], v[120:123], v[72:75]
    v_mfma_f32_16x16x32_bf16 v[76:79], v[232:235], v[124:127], v[76:79]
    v_mfma_f32_16x16x32_bf16 v[80:83], v[232:235], v[128:131], v[80:83]
    v_mfma_f32_16x16x32_bf16 v[84:87], v[232:235], v[132:135], v[84:87]
    s_waitcnt vmcnt(10)
    v_mfma_f32_16x16x32_bf16 v[8:11], v[236:239], v[136:139], v[8:11]
    s_add_u32 s72, s76, 24576
    buffer_load_dwordx4 v[120:123], v3, s[40:43], s72 offen sc1
    v_mfma_f32_16x16x32_bf16 v[12:15], v[236:239], v[140:143], v[12:15]
    ds_read_b128 v[176:179], v7 offset:0
    v_mfma_f32_16x16x32_bf16 v[16:19], v[236:239], v[144:147], v[16:19]
    ds_read_b128 v[180:183], v7 offset:1024
    v_mfma_f32_16x16x32_bf16 v[20:23], v[236:239], v[148:151], v[20:23]
    buffer_load_dwordx4 v[124:127], v4, s[40:43], s72 offen sc1
    v_mfma_f32_16x16x32_bf16 v[24:27], v[240:243], v[136:139], v[24:27]
    ds_read_b128 v[184:187], v7 offset:2048
    v_mfma_f32_16x16x32_bf16 v[28:31], v[240:243], v[140:143], v[28:31]
    ds_read_b128 v[188:191], v7 offset:3072
    v_mfma_f32_16x16x32_bf16 v[32:35], v[240:243], v[144:147], v[32:35]
    buffer_load_dwordx4 v[128:131], v5, s[40:43], s72 offen sc1
    v_mfma_f32_16x16x32_bf16 v[36:39], v[240:243], v[148:151], v[36:39]
    ds_read_b128 v[192:195], v7 offset:4096
    v_mfma_f32_16x16x32_bf16 v[40:43], v[244:247], v[136:139], v[40:43]
    v_mfma_f32_16x16x32_bf16 v[44:47], v[244:247], v[140:143], v[44:47]
    buffer_load_dwordx4 v[132:135], v6, s[40:43], s72 offen sc1
    v_mfma_f32_16x16x32_bf16 v[48:51], v[244:247], v[144:147], v[48:51]
    v_mfma_f32_16x16x32_bf16 v[52:55], v[244:247], v[148:151], v[52:55]
    v_mfma_f32_16x16x32_bf16 v[56:59], v[248:251], v[136:139], v[56:59]
    buffer_load_dwordx4 v[204:207], v1, s[44:47], s73 offen offset:2048 sc1
    v_mfma_f32_16x16x32_bf16 v[60:63], v[248:251], v[140:143], v[60:63]
    v_mfma_f32_16x16x32_bf16 v[64:67], v[248:251], v[144:147], v[64:67]
    v_mfma_f32_16x16x32_bf16 v[68:71], v[248:251], v[148:151], v[68:71]
    buffer_load_dwordx4 v[208:211], v1, s[44:47], s73 offen offset:3072 sc1
    v_mfma_f32_16x16x32_bf16 v[72:75], v[252:255], v[136:139], v[72:75]
    v_mfma_f32_16x16x32_bf16 v[76:79], v[252:255], v[140:143], v[76:79]
    v_mfma_f32_16x16x32_bf16 v[80:83], v[252:255], v[144:147], v[80:83]
    v_mfma_f32_16x16x32_bf16 v[84:87], v[252:255], v[148:151], v[84:87]
    s_waitcnt vmcnt(12)
    v_mfma_f32_16x16x32_bf16 v[8:11], v[156:159], v[88:91], v[8:11]
    buffer_load_dwordx4 v[212:215], v2, s[44:47], s73 offen sc1
    v_mfma_f32_16x16x32_bf16 v[12:15], v[156:159], v[92:95], v[12:15]
    v_mfma_f32_16x16x32_bf16 v[16:19], v[156:159], v[96:99], v[16:19]
    v_mfma_f32_16x16x32_bf16 v[20:23], v[156:159], v[100:103], v[20:23]
    s_add_u32 s72, s76, 28672
    buffer_load_dwordx4 v[136:139], v3, s[40:43], s72 offen sc1
    v_mfma_f32_16x16x32_bf16 v[24:27], v[160:163], v[88:91], v[24:27]
    v_mfma_f32_16x16x32_bf16 v[28:31], v[160:163], v[92:95], v[28:31]
    v_mfma_f32_16x16x32_bf16 v[32:35], v[160:163], v[96:99], v[32:35]
    buffer_load_dwordx4 v[140:143], v4, s[40:43], s72 offen sc1
    v_mfma_f32_16x16x32_bf16 v[36:39], v[160:163], v[100:103], v[36:39]
    v_mfma_f32_16x16x32_bf16 v[40:43], v[164:167], v[88:91], v[40:43]
    v_mfma_f32_16x16x32_bf16 v[44:47], v[164:167], v[92:95], v[44:47]
    buffer_load_dwordx4 v[144:147], v5, s[40:43], s72 offen sc1
    v_mfma_f32_16x16x32_bf16 v[48:51], v[164:167], v[96:99], v[48:51]
    v_mfma_f32_16x16x32_bf16 v[52:55], v[164:167], v[100:103], v[52:55]
    v_mfma_f32_16x16x32_bf16 v[56:59], v[168:171], v[88:91], v[56:59]
    buffer_load_dwordx4 v[148:151], v6, s[40:43], s72 offen sc1
    v_mfma_f32_16x16x32_bf16 v[60:63], v[168:171], v[92:95], v[60:63]
    v_mfma_f32_16x16x32_bf16 v[64:67], v[168:171], v[96:99], v[64:67]
    v_mfma_f32_16x16x32_bf16 v[68:71], v[168:171], v[100:103], v[68:71]
    s_add_u32 s73, s77, 35840
    buffer_load_dwordx4 v[216:219], v1, s[44:47], s73 offen offset:0 sc1
    v_mfma_f32_16x16x32_bf16 v[72:75], v[172:175], v[88:91], v[72:75]
    v_mfma_f32_16x16x32_bf16 v[76:79], v[172:175], v[92:95], v[76:79]
    v_mfma_f32_16x16x32_bf16 v[80:83], v[172:175], v[96:99], v[80:83]
    v_mfma_f32_16x16x32_bf16 v[84:87], v[172:175], v[100:103], v[84:87]
    s_waitcnt vmcnt(14) lgkmcnt(0)
    v_mfma_f32_16x16x32_bf16 v[8:11], v[176:179], v[104:107], v[8:11]
    buffer_load_dwordx4 v[220:223], v1, s[44:47], s73 offen offset:1024 sc1
    v_mfma_f32_16x16x32_bf16 v[12:15], v[176:179], v[108:111], v[12:15]
    v_mfma_f32_16x16x32_bf16 v[16:19], v[176:179], v[112:115], v[16:19]
    v_mfma_f32_16x16x32_bf16 v[20:23], v[176:179], v[116:119], v[20:23]
    buffer_load_dwordx4 v[224:227], v1, s[44:47], s73 offen offset:2048 sc1
    v_mfma_f32_16x16x32_bf16 v[24:27], v[180:183], v[104:107], v[24:27]
    v_mfma_f32_16x16x32_bf16 v[28:31], v[180:183], v[108:111], v[28:31]
    v_mfma_f32_16x16x32_bf16 v[32:35], v[180:183], v[112:115], v[32:35]
    buffer_load_dwordx4 v[228:231], v1, s[44:47], s73 offen offset:3072 sc1
    v_mfma_f32_16x16x32_bf16 v[36:39], v[180:183], v[116:119], v[36:39]
    v_mfma_f32_16x16x32_bf16 v[40:43], v[184:187], v[104:107], v[40:43]
    v_mfma_f32_16x16x32_bf16 v[44:47], v[184:187], v[108:111], v[44:47]
    buffer_load_dwordx4 v[232:235], v2, s[44:47], s73 offen sc1
    v_mfma_f32_16x16x32_bf16 v[48:51], v[184:187], v[112:115], v[48:51]
    v_mfma_f32_16x16x32_bf16 v[52:55], v[184:187], v[116:119], v[52:55]
    v_mfma_f32_16x16x32_bf16 v[56:59], v[188:191], v[104:107], v[56:59]
    s_add_u32 s72, s76, 32768
    buffer_load_dwordx4 v[88:91], v3, s[40:43], s72 offen sc1
    v_mfma_f32_16x16x32_bf16 v[60:63], v[188:191], v[108:111], v[60:63]
    v_mfma_f32_16x16x32_bf16 v[64:67], v[188:191], v[112:115], v[64:67]
    v_mfma_f32_16x16x32_bf16 v[68:71], v[188:191], v[116:119], v[68:71]
    buffer_load_dwordx4 v[92:95], v4, s[40:43], s72 offen sc1
    v_mfma_f32_16x16x32_bf16 v[72:75], v[192:195], v[104:107], v[72:75]
    v_mfma_f32_16x16x32_bf16 v[76:79], v[192:195], v[108:111], v[76:79]
    v_mfma_f32_16x16x32_bf16 v[80:83], v[192:195], v[112:115], v[80:83]
    v_mfma_f32_16x16x32_bf16 v[84:87], v[192:195], v[116:119], v[84:87]
    s_waitcnt vmcnt(11)
    v_mfma_f32_16x16x32_bf16 v[8:11], v[196:199], v[120:123], v[8:11]
    buffer_load_dwordx4 v[96:99], v5, s[40:43], s72 offen sc1
    v_mfma_f32_16x16x32_bf16 v[12:15], v[196:199], v[124:127], v[12:15]
    ds_read_b128 v[236:239], v7 offset:5120
    v_mfma_f32_16x16x32_bf16 v[16:19], v[196:199], v[128:131], v[16:19]
    ds_read_b128 v[240:243], v7 offset:6144
    v_mfma_f32_16x16x32_bf16 v[20:23], v[196:199], v[132:135], v[20:23]
    buffer_load_dwordx4 v[100:103], v6, s[40:43], s72 offen sc1
    v_mfma_f32_16x16x32_bf16 v[24:27], v[200:203], v[120:123], v[24:27]
    ds_read_b128 v[244:247], v7 offset:7168
    v_mfma_f32_16x16x32_bf16 v[28:31], v[200:203], v[124:127], v[28:31]
    ds_read_b128 v[248:251], v7 offset:8192
    v_mfma_f32_16x16x32_bf16 v[32:35], v[200:203], v[128:131], v[32:35]
    s_add_u32 s72, s76, 36864
    buffer_load_dwordx4 v[104:107], v3, s[40:43], s72 offen sc1
    v_mfma_f32_16x16x32_bf16 v[36:39], v[200:203], v[132:135], v[36:39]
    ds_read_b128 v[252:255], v7 offset:9216
    v_mfma_f32_16x16x32_bf16 v[40:43], v[204:207], v[120:123], v[40:43]
    v_mfma_f32_16x16x32_bf16 v[44:47], v[204:207], v[124:127], v[44:47]
    buffer_load_dwordx4 v[108:111], v4, s[40:43], s72 offen sc1
    v_mfma_f32_16x16x32_bf16 v[48:51], v[204:207], v[128:131], v[48:51]
    v_mfma_f32_16x16x32_bf16 v[52:55], v[204:207], v[132:135], v[52:55]
    v_mfma_f32_16x16x32_bf16 v[56:59], v[208:211], v[120:123], v[56:59]
    buffer_load_dwordx4 v[112:115], v5, s[40:43], s72 offen sc1
    v_mfma_f32_16x16x32_bf16 v[60:63], v[208:211], v[124:127], v[60:63]
    v_mfma_f32_16x16x32_bf16 v[64:67], v[208:211], v[128:131], v[64:67]
    v_mfma_f32_16x16x32_bf16 v[68:71], v[208:211], v[132:135], v[68:71]
    buffer_load_dwordx4 v[116:119], v6, s[40:43], s72 offen sc1
    v_mfma_f32_16x16x32_bf16 v[72:75], v[212:215], v[120:123], v[72:75]
    v_mfma_f32_16x16x32_bf16 v[76:79], v[212:215], v[124:127], v[76:79]
    v_mfma_f32_16x16x32_bf16 v[80:83], v[212:215], v[128:131], v[80:83]
    v_mfma_f32_16x16x32_bf16 v[84:87], v[212:215], v[132:135], v[84:87]
    s_waitcnt vmcnt(8)
    v_mfma_f32_16x16x32_bf16 v[8:11], v[216:219], v[136:139], v[8:11]
    s_add_u32 s73, s77, 46080
    buffer_load_dwordx4 v[156:159], v1, s[44:47], s73 offen offset:0 sc1
    v_mfma_f32_16x16x32_bf16 v[12:15], v[216:219], v[140:143], v[12:15]
    ds_write_b32 v152, v152 offset:20
    v_mfma_f32_16x16x32_bf16 v[16:19], v[216:219], v[144:147], v[16:19]
    v_mfma_f32_16x16x32_bf16 v[20:23], v[216:219], v[148:151], v[20:23]
    buffer_load_dwordx4 v[160:163], v1, s[44:47], s73 offen offset:1024 sc1
    v_mfma_f32_16x16x32_bf16 v[24:27], v[220:223], v[136:139], v[24:27]
    v_mfma_f32_16x16x32_bf16 v[28:31], v[220:223], v[140:143], v[28:31]
    v_mfma_f32_16x16x32_bf16 v[32:35], v[220:223], v[144:147], v[32:35]
    buffer_load_dwordx4 v[164:167], v1, s[44:47], s73 offen offset:2048 sc1
    v_mfma_f32_16x16x32_bf16 v[36:39], v[220:223], v[148:151], v[36:39]
    v_mfma_f32_16x16x32_bf16 v[40:43], v[224:227], v[136:139], v[40:43]
    v_mfma_f32_16x16x32_bf16 v[44:47], v[224:227], v[140:143], v[44:47]
    buffer_load_dwordx4 v[168:171], v1, s[44:47], s73 offen offset:3072 sc1
    v_mfma_f32_16x16x32_bf16 v[48:51], v[224:227], v[144:147], v[48:51]
    v_mfma_f32_16x16x32_bf16 v[52:55], v[224:227], v[148:151], v[52:55]
    v_mfma_f32_16x16x32_bf16 v[56:59], v[228:231], v[136:139], v[56:59]
    buffer_load_dwordx4 v[172:175], v2, s[44:47], s73 offen sc1
    v_mfma_f32_16x16x32_bf16 v[60:63], v[228:231], v[140:143], v[60:63]
    v_mfma_f32_16x16x32_bf16 v[64:67], v[228:231], v[144:147], v[64:67]
    v_mfma_f32_16x16x32_bf16 v[68:71], v[228:231], v[148:151], v[68:71]
    s_add_u32 s72, s76, 40960
    buffer_load_dwordx4 v[120:123], v3, s[40:43], s72 offen sc1
    v_mfma_f32_16x16x32_bf16 v[72:75], v[232:235], v[136:139], v[72:75]
    v_mfma_f32_16x16x32_bf16 v[76:79], v[232:235], v[140:143], v[76:79]
    v_mfma_f32_16x16x32_bf16 v[80:83], v[232:235], v[144:147], v[80:83]
    v_mfma_f32_16x16x32_bf16 v[84:87], v[232:235], v[148:151], v[84:87]
    s_waitcnt vmcnt(10) lgkmcnt(0)
    v_mfma_f32_16x16x32_bf16 v[8:11], v[236:239], v[88:91], v[8:11]
    buffer_load_dwordx4 v[124:127], v4, s[40:43], s72 offen sc1
    v_mfma_f32_16x16x32_bf16 v[12:15], v[236:239], v[92:95], v[12:15]
    v_mfma_f32_16x16x32_bf16 v[16:19], v[236:239], v[96:99], v[16:19]
    buffer_load_dwordx4 v[128:131], v5, s[40:43], s72 offen sc1
    v_mfma_f32_16x16x32_bf16 v[20:23], v[236:239], v[100:103], v[20:23]
    v_mfma_f32_16x16x32_bf16 v[24:27], v[240:243], v[88:91], v[24:27]
    buffer_load_dwordx4 v[132:135], v6, s[40:43], s72 offen sc1
    v_mfma_f32_16x16x32_bf16 v[28:31], v[240:243], v[92:95], v[28:31]
    v_mfma_f32_16x16x32_bf16 v[32:35], v[240:243], v[96:99], v[32:35]
    s_add_u32 s73, s77, 51200
    buffer_load_dwordx4 v[176:179], v1, s[44:47], s73 offen offset:0 sc1
    v_mfma_f32_16x16x32_bf16 v[36:39], v[240:243], v[100:103], v[36:39]
    v_mfma_f32_16x16x32_bf16 v[40:43], v[244:247], v[88:91], v[40:43]
    v_mfma_f32_16x16x32_bf16 v[44:47], v[244:247], v[92:95], v[44:47]
    buffer_load_dwordx4 v[180:183], v1, s[44:47], s73 offen offset:1024 sc1
    v_mfma_f32_16x16x32_bf16 v[48:51], v[244:247], v[96:99], v[48:51]
    v_mfma_f32_16x16x32_bf16 v[52:55], v[244:247], v[100:103], v[52:55]
    buffer_load_dwordx4 v[184:187], v1, s[44:47], s73 offen offset:2048 sc1
    v_mfma_f32_16x16x32_bf16 v[56:59], v[248:251], v[88:91], v[56:59]
    v_mfma_f32_16x16x32_bf16 v[60:63], v[248:251], v[92:95], v[60:63]
    buffer_load_dwordx4 v[188:191], v1, s[44:47], s73 offen offset:3072 sc1
    v_mfma_f32_16x16x32_bf16 v[64:67], v[248:251], v[96:99], v[64:67]
    v_mfma_f32_16x16x32_bf16 v[68:71], v[248:251], v[100:103], v[68:71]
    buffer_load_dwordx4 v[192:195], v2, s[44:47], s73 offen sc1
    v_mfma_f32_16x16x32_bf16 v[72:75], v[252:255], v[88:91], v[72:75]
    v_mfma_f32_16x16x32_bf16 v[76:79], v[252:255], v[92:95], v[76:79]
    v_mfma_f32_16x16x32_bf16 v[80:83], v[252:255], v[96:99], v[80:83]
    v_mfma_f32_16x16x32_bf16 v[84:87], v[252:255], v[100:103], v[84:87]
    s_waitcnt vmcnt(9)
    v_mfma_f32_16x16x32_bf16 v[8:11], v[156:159], v[104:107], v[8:11]
    s_add_u32 s72, s76, 45056
    buffer_load_dwordx4 v[136:139], v3, s[40:43], s72 offen sc1
    v_mfma_f32_16x16x32_bf16 v[12:15], v[156:159], v[108:111], v[12:15]
    ds_read_b128 v[196:199], v7 offset:10240
    v_mfma_f32_16x16x32_bf16 v[16:19], v[156:159], v[112:115], v[16:19]
    ds_read_b128 v[200:203], v7 offset:11264
    v_mfma_f32_16x16x32_bf16 v[20:23], v[156:159], v[116:119], v[20:23]
    buffer_load_dwordx4 v[140:143], v4, s[40:43], s72 offen sc1
    v_mfma_f32_16x16x32_bf16 v[24:27], v[160:163], v[104:107], v[24:27]
    ds_read_b128 v[204:207], v7 offset:12288
    v_mfma_f32_16x16x32_bf16 v[28:31], v[160:163], v[108:111], v[28:31]
    ds_read_b128 v[208:211], v7 offset:13312
    v_mfma_f32_16x16x32_bf16 v[32:35], v[160:163], v[112:115], v[32:35]
    buffer_load_dwordx4 v[144:147], v5, s[40:43], s72 offen sc1
    v_mfma_f32_16x16x32_bf16 v[36:39], v[160:163], v[116:119], v[36:39]
    ds_read_b128 v[212:215], v7 offset:14336
    v_mfma_f32_16x16x32_bf16 v[40:43], v[164:167], v[104:107], v[40:43]
    v_mfma_f32_16x16x32_bf16 v[44:47], v[164:167], v[108:111], v[44:47]
    buffer_load_dwordx4 v[148:151], v6, s[40:43], s72 offen sc1
    v_mfma_f32_16x16x32_bf16 v[48:51], v[164:167], v[112:115], v[48:51]
    v_mfma_f32_16x16x32_bf16 v[52:55], v[164:167], v[116:119], v[52:55]
    v_mfma_f32_16x16x32_bf16 v[56:59], v[168:171], v[104:107], v[56:59]
    s_add_u32 s72, s76, 49152
    buffer_load_dwordx4 v[88:91], v3, s[40:43], s72 offen sc1
    v_mfma_f32_16x16x32_bf16 v[60:63], v[168:171], v[108:111], v[60:63]
    v_mfma_f32_16x16x32_bf16 v[64:67], v[168:171], v[112:115], v[64:67]
    v_mfma_f32_16x16x32_bf16 v[68:71], v[168:171], v[116:119], v[68:71]
    buffer_load_dwordx4 v[92:95], v4, s[40:43], s72 offen sc1
    v_mfma_f32_16x16x32_bf16 v[72:75], v[172:175], v[104:107], v[72:75]
    v_mfma_f32_16x16x32_bf16 v[76:79], v[172:175], v[108:111], v[76:79]
    v_mfma_f32_16x16x32_bf16 v[80:83], v[172:175], v[112:115], v[80:83]
    v_mfma_f32_16x16x32_bf16 v[84:87], v[172:175], v[116:119], v[84:87]
    s_waitcnt vmcnt(6)
    v_mfma_f32_16x16x32_bf16 v[8:11], v[176:179], v[120:123], v[8:11]
    buffer_load_dwordx4 v[96:99], v5, s[40:43], s72 offen sc1
    v_mfma_f32_16x16x32_bf16 v[12:15], v[176:179], v[124:127], v[12:15]
    v_mfma_f32_16x16x32_bf16 v[16:19], v[176:179], v[128:131], v[16:19]
    buffer_load_dwordx4 v[100:103], v6, s[40:43], s72 offen sc1
    v_mfma_f32_16x16x32_bf16 v[20:23], v[176:179], v[132:135], v[20:23]
    v_mfma_f32_16x16x32_bf16 v[24:27], v[180:183], v[120:123], v[24:27]
    v_mfma_f32_16x16x32_bf16 v[28:31], v[180:183], v[124:127], v[28:31]
    s_add_u32 s73, s77, 61440
    buffer_load_dwordx4 v[216:219], v1, s[44:47], s73 offen offset:0 sc1
    v_mfma_f32_16x16x32_bf16 v[32:35], v[180:183], v[128:131], v[32:35]
    v_mfma_f32_16x16x32_bf16 v[36:39], v[180:183], v[132:135], v[36:39]
    buffer_load_dwordx4 v[220:223], v1, s[44:47], s73 offen offset:1024 sc1
    v_mfma_f32_16x16x32_bf16 v[40:43], v[184:187], v[120:123], v[40:43]
    v_mfma_f32_16x16x32_bf16 v[44:47], v[184:187], v[124:127], v[44:47]
    v_mfma_f32_16x16x32_bf16 v[48:51], v[184:187], v[128:131], v[48:51]
    buffer_load_dwordx4 v[224:227], v1, s[44:47], s73 offen offset:2048 sc1
    v_mfma_f32_16x16x32_bf16 v[52:55], v[184:187], v[132:135], v[52:55]
    v_mfma_f32_16x16x32_bf16 v[56:59], v[188:191], v[120:123], v[56:59]
    buffer_load_dwordx4 v[228:231], v1, s[44:47], s73 offen offset:3072 sc1
    v_mfma_f32_16x16x32_bf16 v[60:63], v[188:191], v[124:127], v[60:63]
    v_mfma_f32_16x16x32_bf16 v[64:67], v[188:191], v[128:131], v[64:67]
    v_mfma_f32_16x16x32_bf16 v[68:71], v[188:191], v[132:135], v[68:71]
    buffer_load_dwordx4 v[232:235], v2, s[44:47], s73 offen sc1
    v_mfma_f32_16x16x32_bf16 v[72:75], v[192:195], v[120:123], v[72:75]
    v_mfma_f32_16x16x32_bf16 v[76:79], v[192:195], v[124:127], v[76:79]
    v_mfma_f32_16x16x32_bf16 v[80:83], v[192:195], v[128:131], v[80:83]
    v_mfma_f32_16x16x32_bf16 v[84:87], v[192:195], v[132:135], v[84:87]
    s_waitcnt vmcnt(9) lgkmcnt(0)
    v_mfma_f32_16x16x32_bf16 v[8:11], v[196:199], v[136:139], v[8:11]
    s_add_u32 s72, s76, 53248
    s_add_u32 s72, s72, s79
    buffer_load_dwordx4 v[104:107], v3, s[40:43], s72 offen sc1
    v_mfma_f32_16x16x32_bf16 v[12:15], v[196:199], v[140:143], v[12:15]
    v_mfma_f32_16x16x32_bf16 v[16:19], v[196:199], v[144:147], v[16:19]
    buffer_load_dwordx4 v[108:111], v4, s[40:43], s72 offen sc1
    v_mfma_f32_16x16x32_bf16 v[20:23], v[196:199], v[148:151], v[20:23]
    v_mfma_f32_16x16x32_bf16 v[24:27], v[200:203], v[136:139], v[24:27]
    buffer_load_dwordx4 v[112:115], v5, s[40:43], s72 offen sc1
    v_mfma_f32_16x16x32_bf16 v[28:31], v[200:203], v[140:143], v[28:31]
    v_mfma_f32_16x16x32_bf16 v[32:35], v[200:203], v[144:147], v[32:35]
    buffer_load_dwordx4 v[116:119], v6, s[40:43], s72 offen sc1
    v_mfma_f32_16x16x32_bf16 v[36:39], v[200:203], v[148:151], v[36:39]
    v_mfma_f32_16x16x32_bf16 v[40:43], v[204:207], v[136:139], v[40:43]
    s_add_u32 s73, s77, 66560
    s_add_u32 s73, s73, s79
    buffer_load_dwordx4 v[236:239], v1, s[44:47], s73 offen offset:0 sc1
    v_mfma_f32_16x16x32_bf16 v[44:47], v[204:207], v[140:143], v[44:47]
    v_mfma_f32_16x16x32_bf16 v[48:51], v[204:207], v[144:147], v[48:51]
    buffer_load_dwordx4 v[240:243], v1, s[44:47], s73 offen offset:1024 sc1
    v_mfma_f32_16x16x32_bf16 v[52:55], v[204:207], v[148:151], v[52:55]
    v_mfma_f32_16x16x32_bf16 v[56:59], v[208:211], v[136:139], v[56:59]
    buffer_load_dwordx4 v[244:247], v1, s[44:47], s73 offen offset:2048 sc1
    v_mfma_f32_16x16x32_bf16 v[60:63], v[208:211], v[140:143], v[60:63]
    v_mfma_f32_16x16x32_bf16 v[64:67], v[208:211], v[144:147], v[64:67]
    buffer_load_dwordx4 v[248:251], v1, s[44:47], s73 offen offset:3072 sc1
    v_mfma_f32_16x16x32_bf16 v[68:71], v[208:211], v[148:151], v[68:71]
    v_mfma_f32_16x16x32_bf16 v[72:75], v[212:215], v[136:139], v[72:75]
    buffer_load_dwordx4 v[252:255], v2, s[44:47], s73 offen sc1
    v_mfma_f32_16x16x32_bf16 v[76:79], v[212:215], v[140:143], v[76:79]
    v_mfma_f32_16x16x32_bf16 v[80:83], v[212:215], v[144:147], v[80:83]
    v_mfma_f32_16x16x32_bf16 v[84:87], v[212:215], v[148:151], v[84:87]
    s_waitcnt vmcnt(9)
    v_mfma_f32_16x16x32_bf16 v[8:11], v[216:219], v[88:91], v[8:11]
    s_mov_b32 s48, s34
    s_mov_b32 s49, s35
    v_mfma_f32_16x16x32_bf16 v[12:15], v[216:219], v[92:95], v[12:15]
    s_mov_b32 s50, 0x280000
    s_mov_b32 s51, 0x20000
    v_mfma_f32_16x16x32_bf16 v[16:19], v[216:219], v[96:99], v[16:19]
    s_lshl_b32 s53, s8, 2
    s_add_u32 s53, s53, s101
    v_mfma_f32_16x16x32_bf16 v[20:23], v[216:219], v[100:103], v[20:23]
    s_mul_i32 s54, s53, 20480
    s_mul_i32 s55, s9, 160
    v_mfma_f32_16x16x32_bf16 v[24:27], v[220:223], v[88:91], v[24:27]
    s_add_u32 s54, s54, s55
    v_add_u32 v159, 0, v0
    v_mfma_f32_16x16x32_bf16 v[28:31], v[220:223], v[92:95], v[28:31]
    v_mul_u32_u24 v160, 10923, v159
    v_lshrrev_b32 v160, 16, v160
    v_mfma_f32_16x16x32_bf16 v[32:35], v[220:223], v[96:99], v[32:35]
    v_mul_u32_u24 v160, 1184, v160
    v_lshl_add_u32 v156, v159, 4, v160
    v_mfma_f32_16x16x32_bf16 v[36:39], v[220:223], v[100:103], v[36:39]
    v_add_u32 v159, 64, v0
    v_mul_u32_u24 v160, 10923, v159
    v_mfma_f32_16x16x32_bf16 v[40:43], v[224:227], v[88:91], v[40:43]
    v_lshrrev_b32 v160, 16, v160
    v_mul_u32_u24 v160, 1184, v160
    v_mfma_f32_16x16x32_bf16 v[44:47], v[224:227], v[92:95], v[44:47]
    v_lshl_add_u32 v157, v159, 4, v160
    v_mov_b32 v160, 1073741824
    v_mfma_f32_16x16x32_bf16 v[48:51], v[224:227], v[96:99], v[48:51]
    v_cmp_gt_u32 vcc, 32, v0
    s_nop 1
    v_cndmask_b32 v157, v160, v157, vcc
    v_mfma_f32_16x16x32_bf16 v[52:55], v[224:227], v[100:103], v[52:55]
    v_xor_b32 v161, 16384, v7
    v_xor_b32 v162, 32768, v7
    v_mfma_f32_16x16x32_bf16 v[56:59], v[228:231], v[88:91], v[56:59]
    v_xor_b32 v163, 49152, v7
    v_add_u32 v164, s81, v1
    v_mfma_f32_16x16x32_bf16 v[60:63], v[228:231], v[92:95], v[60:63]
    v_and_b32 v165, 15, v0
    v_mul_u32_u24 v165, 96, v165
    v_mfma_f32_16x16x32_bf16 v[64:67], v[228:231], v[96:99], v[64:67]
    v_lshrrev_b32 v166, 4, v0
    v_lshl_add_u32 v165, v166, 3, v165
    v_mfma_f32_16x16x32_bf16 v[68:71], v[228:231], v[100:103], v[68:71]
    v_add_u32 v165, s81, v165
    v_mov_b32 v168, 1.0
    v_mfma_f32_16x16x32_bf16 v[72:75], v[232:235], v[88:91], v[72:75]
    v_mov_b32 v169, 1.0
    v_mfma_f32_16x16x32_bf16 v[76:79], v[232:235], v[92:95], v[76:79]
    v_mfma_f32_16x16x32_bf16 v[80:83], v[232:235], v[96:99], v[80:83]
    v_mfma_f32_16x16x32_bf16 v[84:87], v[232:235], v[100:103], v[84:87]
    s_waitcnt vmcnt(0) lgkmcnt(0)
    s_setprio 2
    s_cmp_ge_u32 s101, 2
    s_cbranch_scc1 L_g2_short
    v_mfma_f32_16x16x32_bf16 v[56:59], v[248:251], v[104:107], v[56:59]
    v_mfma_f32_16x16x32_bf16 v[72:75], v[252:255], v[104:107], v[72:75]
    v_mfma_f32_16x16x32_bf16 v[12:15], v[236:239], v[108:111], v[12:15]
    v_mfma_f32_16x16x32_bf16 v[28:31], v[240:243], v[108:111], v[28:31]
    v_mfma_f32_16x16x32_bf16 v[44:47], v[244:247], v[108:111], v[44:47]
    v_mfma_f32_16x16x32_bf16 v[60:63], v[248:251], v[108:111], v[60:63]
    v_mfma_f32_16x16x32_bf16 v[76:79], v[252:255], v[108:111], v[76:79]
    s_nop 1
    ds_write_b128 v164, v[56:59] offset:9216
    v_mfma_f32_16x16x32_bf16 v[16:19], v[236:239], v[112:115], v[16:19]
    ds_write_b128 v164, v[72:75] offset:10240
    v_mfma_f32_16x16x32_bf16 v[32:35], v[240:243], v[112:115], v[32:35]
    ds_write_b128 v7, v[12:15] offset:0
    v_mfma_f32_16x16x32_bf16 v[48:51], v[244:247], v[112:115], v[48:51]
    ds_write_b128 v7, v[28:31] offset:1024
    v_mfma_f32_16x16x32_bf16 v[64:67], v[248:251], v[112:115], v[64:67]
    ds_write_b128 v7, v[44:47] offset:2048
    v_mfma_f32_16x16x32_bf16 v[80:83], v[252:255], v[112:115], v[80:83]
    ds_write_b128 v7, v[60:63] offset:3072
    v_mfma_f32_16x16x32_bf16 v[20:23], v[236:239], v[116:119], v[20:23]
    ds_write_b128 v7, v[76:79] offset:4096
    v_mfma_f32_16x16x32_bf16 v[36:39], v[240:243], v[116:119], v[36:39]
    ds_write_b128 v7, v[16:19] offset:5120
    v_mfma_f32_16x16x32_bf16 v[52:55], v[244:247], v[116:119], v[52:55]
    ds_write_b128 v7, v[32:35] offset:6144
    v_mfma_f32_16x16x32_bf16 v[68:71], v[248:251], v[116:119], v[68:71]
    ds_write_b128 v7, v[48:51] offset:7168
    v_mfma_f32_16x16x32_bf16 v[84:87], v[252:255], v[116:119], v[84:87]
    ds_write_b128 v7, v[64:67] offset:8192
    v_mfma_f32_16x16x32_bf16 v[8:11], v[236:239], v[104:107], v[8:11]
    ds_write_b128 v7, v[80:83] offset:9216
    v_mfma_f32_16x16x32_bf16 v[24:27], v[240:243], v[104:107], v[24:27]
    ds_write_b128 v7, v[20:23] offset:10240
    v_mfma_f32_16x16x32_bf16 v[40:43], v[244:247], v[104:107], v[40:43]
    ds_write_b128 v7, v[36:39] offset:11264
    ds_write_b128 v7, v[52:55] offset:12288
    ds_write_b128 v7, v[68:71] offset:13312
    ds_write_b128 v7, v[84:87] offset:14336
    s_branch L_g2_join
L_g2_short:
    s_nop 7
    ds_write_b128 v164, v[56:59] offset:9216
    ds_write_b128 v164, v[72:75] offset:10240
    ds_write_b128 v7, v[12:15] offset:0
    ds_write_b128 v7, v[28:31] offset:1024
    ds_write_b128 v7, v[44:47] offset:2048
    ds_write_b128 v7, v[60:63] offset:3072
    ds_write_b128 v7, v[76:79] offset:4096
    ds_write_b128 v7, v[16:19] offset:5120
    ds_write_b128 v7, v[32:35] offset:6144
    ds_write_b128 v7, v[48:51] offset:7168
    ds_write_b128 v7, v[64:67] offset:8192
    ds_write_b128 v7, v[80:83] offset:9216
    ds_write_b128 v7, v[20:23] offset:10240
    ds_write_b128 v7, v[36:39] offset:11264
    ds_write_b128 v7, v[52:55] offset:12288
    ds_write_b128 v7, v[68:71] offset:13312
    ds_write_b128 v7, v[84:87] offset:14336
L_g2_join:
    s_waitcnt lgkmcnt(0)
    s_barrier
    ds_read_b64 v[170:171], v164 offset:16384
    ds_read_b128 v[12:15], v161 offset:0
    ds_read_b128 v[16:19], v162 offset:5120
    ds_read_b128 v[20:23], v163 offset:10240
    ds_read_b128 v[88:91], v164 offset:6144
    ds_read_b128 v[108:111], v164 offset:11264
    ds_read_b128 v[28:31], v161 offset:1024
    ds_read_b128 v[32:35], v162 offset:6144
    ds_read_b128 v[36:39], v163 offset:11264
    ds_read_b128 v[92:95], v164 offset:7168
    ds_read_b128 v[112:115], v164 offset:12288
    ds_read_b128 v[44:47], v161 offset:2048
    ds_read_b128 v[48:51], v162 offset:7168
    ds_read_b128 v[52:55], v163 offset:12288
    ds_read_b128 v[96:99], v164 offset:8192
    ds_read_b128 v[116:119], v164 offset:13312
    s_waitcnt lgkmcnt(10)
    v_pk_add_f32 v[8:9], v[8:9], v[12:13]
    v_pk_add_f32 v[16:17], v[16:17], v[20:21]
    v_pk_add_f32 v[10:11], v[10:11], v[14:15]
    v_pk_add_f32 v[18:19], v[18:19], v[22:23]
    v_pk_add_f32 v[8:9], v[8:9], v[16:17]
    v_pk_add_f32 v[10:11], v[10:11], v[18:19]
    v_pk_mul_f32 v[12:13], v[8:9], v[170:171]
    v_pk_mul_f32 v[14:15], v[10:11], v[170:171]
    v_exp_f32 v12, v12
    v_exp_f32 v13, v13
    v_exp_f32 v14, v14
    v_exp_f32 v15, v15
    v_pk_mul_f32 v[8:9], v[8:9], v[88:89]
    v_pk_mul_f32 v[10:11], v[10:11], v[90:91]
    v_pk_add_f32 v[12:13], v[12:13], v[168:169]
    v_pk_add_f32 v[14:15], v[14:15], v[168:169]
    v_rcp_f32 v12, v12
    v_rcp_f32 v13, v13
    v_rcp_f32 v14, v14
    v_rcp_f32 v15, v15
    v_pk_fma_f32 v[8:9], v[8:9], v[12:13], v[108:109]
    v_pk_fma_f32 v[10:11], v[10:11], v[14:15], v[110:111]
    v_cvt_pk_bf16_f32 v16, v8, v9
    v_cvt_pk_bf16_f32 v17, v10, v11
    s_waitcnt lgkmcnt(5)
    v_pk_add_f32 v[24:25], v[24:25], v[28:29]
    v_pk_add_f32 v[32:33], v[32:33], v[36:37]
    v_pk_add_f32 v[26:27], v[26:27], v[30:31]
    v_pk_add_f32 v[34:35], v[34:35], v[38:39]
    v_pk_add_f32 v[24:25], v[24:25], v[32:33]
    v_pk_add_f32 v[26:27], v[26:27], v[34:35]
    v_pk_mul_f32 v[28:29], v[24:25], v[170:171]
    v_pk_mul_f32 v[30:31], v[26:27], v[170:171]
    v_exp_f32 v28, v28
    v_exp_f32 v29, v29
    v_exp_f32 v30, v30
    v_exp_f32 v31, v31
    v_pk_mul_f32 v[24:25], v[24:25], v[92:93]
    v_pk_mul_f32 v[26:27], v[26:27], v[94:95]
    v_pk_add_f32 v[28:29], v[28:29], v[168:169]
    v_pk_add_f32 v[30:31], v[30:31], v[168:169]
    v_rcp_f32 v28, v28
    v_rcp_f32 v29, v29
    v_rcp_f32 v30, v30
    v_rcp_f32 v31, v31
    v_pk_fma_f32 v[24:25], v[24:25], v[28:29], v[112:113]
    v_pk_fma_f32 v[26:27], v[26:27], v[30:31], v[114:115]
    v_cvt_pk_bf16_f32 v32, v24, v25
    v_cvt_pk_bf16_f32 v33, v26, v27
    s_waitcnt lgkmcnt(0)
    v_pk_add_f32 v[40:41], v[40:41], v[44:45]
    v_pk_add_f32 v[48:49], v[48:49], v[52:53]
    v_pk_add_f32 v[42:43], v[42:43], v[46:47]
    v_pk_add_f32 v[50:51], v[50:51], v[54:55]
    v_pk_add_f32 v[40:41], v[40:41], v[48:49]
    v_pk_add_f32 v[42:43], v[42:43], v[50:51]
    v_pk_mul_f32 v[44:45], v[40:41], v[170:171]
    v_pk_mul_f32 v[46:47], v[42:43], v[170:171]
    v_exp_f32 v44, v44
    v_exp_f32 v45, v45
    v_exp_f32 v46, v46
    v_exp_f32 v47, v47
    v_pk_mul_f32 v[40:41], v[40:41], v[96:97]
    v_pk_mul_f32 v[42:43], v[42:43], v[98:99]
    v_pk_add_f32 v[44:45], v[44:45], v[168:169]
    v_pk_add_f32 v[46:47], v[46:47], v[168:169]
    v_rcp_f32 v44, v44
    v_rcp_f32 v45, v45
    v_rcp_f32 v46, v46
    v_rcp_f32 v47, v47
    v_pk_fma_f32 v[40:41], v[40:41], v[44:45], v[116:117]
    v_pk_fma_f32 v[42:43], v[42:43], v[46:47], v[118:119]
    v_cvt_pk_bf16_f32 v48, v40, v41
    v_cvt_pk_bf16_f32 v49, v42, v43
    ds_write_b64 v165, v[16:17] offset:0
    ds_write_b64 v165, v[32:33] offset:32
    ds_write_b64 v165, v[48:49] offset:64
    s_waitcnt lgkmcnt(0)
    ds_read_b128 v[128:131], v164 offset:0
    ds_read_b128 v[132:135], v164 offset:1024
    s_waitcnt lgkmcnt(1)
    buffer_store_dwordx4 v[128:131], v156, s[48:51], s54 offen
    s_waitcnt lgkmcnt(0)
    buffer_store_dwordx4 v[132:135], v157, s[48:51], s54 offen
    s_endpgm
L_end:
    s_endpgm
.section .rodata,"a"
.p2align 6
.amdhsa_kernel recurrent_scan__ssm_conv_h3__dense_activation_relu__prompt_kernel
  .amdhsa_next_free_vgpr 256
  .amdhsa_next_free_sgpr 102
  .amdhsa_accum_offset 256
  .amdhsa_group_segment_fixed_size 0
  .amdhsa_kernarg_size 96
  .amdhsa_user_sgpr_count 2
  .amdhsa_user_sgpr_kernarg_segment_ptr 1
  .amdhsa_system_sgpr_workgroup_id_x 1
.end_amdhsa_kernel
```
